```python
import torch

def _softmax(x, axis=-1):
    return torch.softmax(x, dim=axis)
def _gelu(x):
    return torch.nn.functional.gelu(x, approximate="tanh")
def _silu(x):
    return torch.nn.functional.silu(x)
def _sigmoid(x):
    return torch.sigmoid(x)
def _layernorm(x, axis=-1, eps=1e-5):
    m = x.mean(dim=axis, keepdim=True)
    v = x.var(dim=axis, keepdim=True, unbiased=False)
    return (x - m) / torch.sqrt(v + eps)
def _scatter_add(tgt, idx, src, axis=0):
    return tgt.clone().index_add_(axis, idx, src)
def _segment_sum(src, seg, n):
    out = torch.zeros((n,) + src.shape[1:], dtype=src.dtype)
    return out.index_add_(0, seg, src)
def _pad(x, pw):
    flat = tuple(v for pair in reversed(pw) for v in pair)
    return torch.nn.functional.pad(x, flat)

kernel_name = 'gather_scatter__edge_featured_mpnn_egc__graph'

def setup_inputs():

    _w = (lambda a: (lambda t: t.to(torch.bfloat16) if t.is_floating_point() else t)(torch.as_tensor(a)))
    N, deg, D, De = 10000, 16, 256, max(16, 1)
    E = N * deg
    return {
        "x": _w((lambda *s: torch.randn(*s, dtype=torch.bfloat16) * 0.1)(N, D)),
        "e_attr": _w((lambda *s: torch.randn(*s, dtype=torch.bfloat16) * 0.1)(E, De)),
        "src": _w((lambda lo, hi, *s: torch.randint(lo, hi, s))(0, N, E).to(torch.int64)),
        "dst": _w((lambda lo, hi, *s: torch.randint(lo, hi, s))(0, N, E).to(torch.int64)),
        "u_w": _w((lambda *s: torch.randn(*s, dtype=torch.bfloat16) * 0.05)(D, D)),
        "v_w": _w((lambda *s: torch.randn(*s, dtype=torch.bfloat16) * 0.05)(D, D)),
        "g_w": _w((lambda *s: torch.randn(*s, dtype=torch.bfloat16) * 0.1)(2 * D + De, D)),
    }

def reference(x, e_attr, src, dst, u_w, v_w, g_w):
    N, D = x.shape
    g_in = torch.concatenate([x[dst], x[src], e_attr], axis=-1)
    eta = _sigmoid(g_in @ g_w)
    hv = x @ v_w
    msg = eta * hv[src]
    agg = _segment_sum(msg, dst, N)
    return _silu(x @ u_w + agg)
```

```asm
; @launch grid=(256,1,1) block=(512,1,1) lds=163840
.amdgcn_target "amdgcn-amd-amdhsa--gfx950"
.text
.globl gather_scatter__edge_featured_mpnn_egc__graph_kernel
.p2align 8
.type gather_scatter__edge_featured_mpnn_egc__graph_kernel,@function
gather_scatter__edge_featured_mpnn_egc__graph_kernel:
  s_cmp_ge_u32 s2, 256
  s_cbranch_scc1 K1_END
  s_load_dwordx16 s[16:31], s[0:1], 0
  s_load_dwordx4 s[32:35], s[0:1], 64
  s_getpc_b64 s[8:9]
K1_PC:
  s_lshr_b32 s12, s2, 3
  s_and_b32 s12, s12, 31
  s_lshl_b32 s12, s12, 7
  v_lshlrev_b32 v60, 12, v0
  v_add_u32 v60, s12, v60
  v_cmp_gt_u32 vcc, CODE_END-K1_PC, v60
  s_and_saveexec_b64 s[10:11], vcc
  s_cbranch_execz K1_NOPF
  global_load_dword v60, v60, s[8:9]
K1_NOPF:
  s_mov_b64 exec, s[10:11]
  v_lshrrev_b32 v1, 6, v0
  v_and_b32 v2, 63, v0
  v_readfirstlane_b32 s4, v1
  s_and_b32 s15, s2, 7
  s_lshr_b32 s6, s2, 3
  s_mov_b32 s85, 0
  v_mov_b32 v61, 0
  s_cmp_lt_u32 s2, 80
  s_cbranch_scc0 K1_NPART
  v_mov_b32 v40, 0
  v_lshlrev_b32 v41, 2, v0
  v_add_u32 v42, 152000, v41
  ds_write_b32 v42, v40
  v_mov_b32 v40, 0x100
  v_lshlrev_b32 v6, 4, v0
  s_lshr_b32 s5, s6, 1
  s_lshl_b32 s5, s5, 3
  s_add_u32 s5, s5, s15
  s_and_b32 s7, s6, 1
  s_mul_i32 s8, s5, 16000
  s_mul_i32 s9, s5, 128000
  s_movk_i32 s58, 0x2000
  s_waitcnt lgkmcnt(0)
  s_add_u32 s36, s22, s8
  s_addc_u32 s37, s23, 0
  s_mov_b32 s38, 16000
  s_mov_b32 s39, 0x20000
  s_add_u32 s40, s20, s8
  s_addc_u32 s41, s21, 0
  s_mov_b32 s42, 16000
  s_mov_b32 s43, 0x20000
  buffer_load_dwordx4 v[8:11], v6, s[36:39], 0 offen
  buffer_load_dwordx4 v[12:15], v6, s[36:39], s58 offen
  buffer_load_dwordx4 v[16:19], v6, s[40:43], 0 offen
  buffer_load_dwordx4 v[20:23], v6, s[40:43], s58 offen
  s_branch K1_PART
K1_NPART:
  s_and_b32 s7, s15, 3
  s_lshr_b32 s8, s15, 2
  s_mul_i32 s5, s8, 5000
  s_sub_u32 s59, s6, 12
  s_mul_i32 s8, s59, 250
  s_add_u32 s5, s5, s8
  v_and_b32 v3, 31, v2
  v_lshrrev_b32 v4, 5, v2
  v_lshrrev_b32 v8, 3, v2
  v_bfe_u32 v9, v2, 4, 1
  v_bfe_u32 v10, v2, 2, 1
  v_xor_b32 v9, v9, v10
  v_lshlrev_b32 v8, 9, v8
  v_lshl_add_u32 v8, v9, 6, v8
  v_and_b32 v9, 3, v2
  v_lshl_add_u32 v8, v9, 4, v8
  s_lshl_b32 s60, s7, 7
  v_add_u32 v8, s60, v8
  s_lshl_b32 s54, s4, 12
  s_lshl_b32 s55, s4, 14
  s_cmp_lt_u32 s2, 96
  s_cbranch_scc1 K1_AUX
  v_xor_b32 v9, v3, v4
  v_lshlrev_b32 v9, 4, v9
  v_lshl_add_u32 v9, v4, 9, v9
  v_xor_b32 v12, 0, v9
  v_xor_b32 v13, 32, v9
  v_add_u32 v13, 1024, v13
  v_xor_b32 v14, 64, v9
  v_add_u32 v14, 2048, v14
  v_xor_b32 v15, 96, v9
  v_add_u32 v15, 3072, v15
  v_xor_b32 v16, 128, v9
  v_add_u32 v16, 4096, v16
  v_xor_b32 v17, 160, v9
  v_add_u32 v17, 5120, v17
  v_xor_b32 v18, 192, v9
  v_add_u32 v18, 6144, v18
  v_xor_b32 v19, 224, v9
  v_add_u32 v19, 7168, v19
  s_and_b32 s56, s4, 1
  s_lshl_b32 s56, s56, 13
  s_bfe_u32 s61, s4, 0x10001
  s_and_b32 s70, s15, 4
  s_lshl_b32 s70, s70, 3
  s_add_u32 s8, s70, s6
  s_mul_i32 s5, s8, 5000
  s_add_u32 s5, s5, 63
  s_lshr_b32 s5, s5, 6
  s_lshl_b32 s5, s5, 1
  s_add_u32 s8, s7, s61
  s_add_u32 s8, s8, 4294967295
  s_cmp_ge_u32 s8, 5
  s_cselect_b32 s9, 5, 0
  s_sub_u32 s8, s8, s9
  s_lshl_b32 s66, s8, 14
  s_add_u32 s66, s66, 65536
  s_lshl_b32 s62, s8, 5
  s_add_u32 s62, s62, s5
  s_mov_b32 s8, s7
  s_cmp_ge_u32 s8, 3
  s_cselect_b32 s9, 3, 0
  s_sub_u32 s8, s8, s9
  s_mul_i32 s9, s59, 3
  s_add_u32 s8, s8, s9
  s_mul_i32 s9, s8, 52
  s_lshr_b32 s9, s9, 8
  s_mul_i32 s71, s9, 5
  s_sub_u32 s71, s8, s71
  s_lshl_b32 s71, s71, 5
  s_add_u32 s9, s9, s70
  s_mul_i32 s72, s9, 5000
  s_add_u32 s72, s72, 63
  s_lshr_b32 s72, s72, 6
  s_lshl_b32 s72, s72, 1
  s_add_u32 s72, s72, s71
  s_cmp_eq_u32 s61, 0
  s_cselect_b32 s62, s72, s62
  s_cselect_b32 s66, 147456, s66
  s_waitcnt lgkmcnt(0)
  s_mov_b32 s36, s16
  s_mov_b32 s37, s17
  s_mov_b32 s38, 5120000
  s_mov_b32 s39, 0x20000
  s_mov_b32 s44, s26
  s_mov_b32 s45, s27
  s_mov_b32 s46, 131072
  s_mov_b32 s47, 0x20000
  s_add_u32 s40, s28, 131072
  s_addc_u32 s41, s29, 0
  s_mov_b32 s42, 131072
  s_mov_b32 s43, 0x20000
  s_cmp_ge_u32 s4, 4
  s_cbranch_scc0 K1_LO
  s_cmp_ge_u32 s4, 6
  s_cbranch_scc1 K1_NT
  v_min_u32 v20, 12, v2
  v_lshlrev_b32 v20, 9, v20
  s_mul_i32 s8, s59, 6656
  s_add_u32 s8, s8, s60
  s_cmp_eq_u32 s4, 4
  s_cbranch_scc1 K1_TP
  buffer_load_dword v21, v20, s[44:47], s8 offen
  s_branch K1_NT
K1_TP:
  buffer_load_dword v21, v20, s[40:43], s8 offen
K1_NT:
  s_barrier
  s_add_u32 m0, s54, 0
  s_add_u32 s8, s55, 0
  buffer_load_dwordx4 v8, s[40:43], s8 offen lds
  s_add_u32 m0, s54, 32768
  s_nop 0
  buffer_load_dwordx4 v8, s[44:47], s8 offen lds
  s_add_u32 m0, s54, 1024
  s_add_u32 s8, s55, 4096
  buffer_load_dwordx4 v8, s[40:43], s8 offen lds
  s_add_u32 m0, s54, 33792
  s_nop 0
  buffer_load_dwordx4 v8, s[44:47], s8 offen lds
  s_add_u32 m0, s54, 2048
  s_add_u32 s8, s55, 8192
  buffer_load_dwordx4 v8, s[40:43], s8 offen lds
  s_add_u32 m0, s54, 34816
  s_nop 0
  buffer_load_dwordx4 v8, s[44:47], s8 offen lds
  s_add_u32 m0, s54, 3072
  s_add_u32 s8, s55, 12288
  buffer_load_dwordx4 v8, s[40:43], s8 offen lds
  s_add_u32 m0, s54, 35840
  s_nop 0
  buffer_load_dwordx4 v8, s[44:47], s8 offen lds
  s_branch K1_HI
K1_LO:
  s_lshl_b32 s57, s62, 9
  s_add_u32 s57, s57, s56
  s_add_u32 s58, s66, s56
  s_add_u32 m0, s58, 0
  s_nop 0
  buffer_load_dwordx4 v12, s[36:39], s57 offen lds
  s_add_u32 m0, s58, 1024
  s_nop 0
  buffer_load_dwordx4 v13, s[36:39], s57 offen lds
  s_add_u32 m0, s58, 2048
  s_nop 0
  buffer_load_dwordx4 v14, s[36:39], s57 offen lds
  s_add_u32 m0, s58, 3072
  s_nop 0
  buffer_load_dwordx4 v15, s[36:39], s57 offen lds
  s_add_u32 m0, s58, 4096
  s_nop 0
  buffer_load_dwordx4 v16, s[36:39], s57 offen lds
  s_add_u32 m0, s58, 5120
  s_nop 0
  buffer_load_dwordx4 v17, s[36:39], s57 offen lds
  s_add_u32 m0, s58, 6144
  s_nop 0
  buffer_load_dwordx4 v18, s[36:39], s57 offen lds
  s_add_u32 m0, s58, 7168
  s_nop 0
  buffer_load_dwordx4 v19, s[36:39], s57 offen lds
  s_barrier
  s_add_u32 m0, s54, 0
  s_add_u32 s8, s55, 0
  buffer_load_dwordx4 v8, s[40:43], s8 offen lds
  s_add_u32 m0, s54, 32768
  s_nop 0
  buffer_load_dwordx4 v8, s[44:47], s8 offen lds
  s_add_u32 m0, s54, 1024
  s_add_u32 s8, s55, 4096
  buffer_load_dwordx4 v8, s[40:43], s8 offen lds
  s_add_u32 m0, s54, 33792
  s_nop 0
  buffer_load_dwordx4 v8, s[44:47], s8 offen lds
  s_add_u32 m0, s54, 2048
  s_add_u32 s8, s55, 8192
  buffer_load_dwordx4 v8, s[40:43], s8 offen lds
  s_add_u32 m0, s54, 34816
  s_nop 0
  buffer_load_dwordx4 v8, s[44:47], s8 offen lds
  s_add_u32 m0, s54, 3072
  s_add_u32 s8, s55, 12288
  buffer_load_dwordx4 v8, s[40:43], s8 offen lds
  s_add_u32 m0, s54, 35840
  s_nop 0
  buffer_load_dwordx4 v8, s[44:47], s8 offen lds
  s_add_u32 s8, s7, s61
  s_add_u32 s8, s8, 1
  s_cmp_ge_u32 s8, 5
  s_cselect_b32 s9, 5, 0
  s_sub_u32 s8, s8, s9
  s_lshl_b32 s67, s8, 14
  s_add_u32 s67, s67, 65536
  s_lshl_b32 s63, s8, 5
  s_add_u32 s63, s63, s5
  s_add_u32 s8, s7, s61
  s_add_u32 s8, s8, 3
  s_cmp_ge_u32 s8, 5
  s_cselect_b32 s9, 5, 0
  s_sub_u32 s8, s8, s9
  s_lshl_b32 s68, s8, 14
  s_add_u32 s68, s68, 65536
  s_lshl_b32 s64, s8, 5
  s_add_u32 s64, s64, s5
  s_add_u32 s8, s7, s61
  s_add_u32 s8, s8, 1
  s_cmp_ge_u32 s8, 3
  s_cselect_b32 s9, 3, 0
  s_sub_u32 s8, s8, s9
  s_mul_i32 s9, s59, 3
  s_add_u32 s8, s8, s9
  s_mul_i32 s9, s8, 52
  s_lshr_b32 s9, s9, 8
  s_mul_i32 s71, s9, 5
  s_sub_u32 s71, s8, s71
  s_lshl_b32 s71, s71, 5
  s_add_u32 s9, s9, s70
  s_mul_i32 s65, s9, 5000
  s_add_u32 s65, s65, 63
  s_lshr_b32 s65, s65, 6
  s_lshl_b32 s65, s65, 1
  s_add_u32 s65, s65, s71
  s_lshl_b32 s69, s61, 14
  s_mov_b32 s10, 0x7f000000
  s_mov_b32 s11, 0xffff0000
  v_and_b32 v5, 15, v3
  v_xor_b32 v5, v5, v4
  v_lshlrev_b32 v5, 4, v5
  v_lshl_add_u32 v5, v3, 9, v5
  v_add_u32 v5, s66, v5
  s_sub_u32 s78, s68, s66
  v_xor_b32 v72, 0, v5
  v_xor_b32 v73, 32, v5
  v_xor_b32 v74, 64, v5
  v_xor_b32 v75, 96, v5
  v_xor_b32 v76, 128, v5
  v_xor_b32 v77, 160, v5
  v_xor_b32 v78, 192, v5
  v_xor_b32 v79, 224, v5
  v_bfe_u32 v6, v2, 2, 2
  v_lshl_add_u32 v7, v4, 3, v6
  v_lshlrev_b32 v7, 7, v7
  v_lshrrev_b32 v6, 1, v6
  v_lshl_add_u32 v7, v6, 6, v7
  v_bfe_u32 v6, v2, 4, 1
  v_lshl_add_u32 v7, v6, 5, v7
  v_and_b32 v6, 3, v2
  v_lshl_add_u32 v7, v6, 3, v7
  s_and_b32 s8, s4, 1
  s_lshl_b32 s9, s8, 6
  v_xor_b32 v6, s9, v7
  v_lshlrev_b32 v7, 10, v4
  v_lshl_add_u32 v7, v3, 2, v7
  s_lshl_b32 s8, s8, 7
  v_add_u32 v7, s8, v7
  v_mov_b32 v38, 0xbfb8aa3b
  v_mov_b32 v39, 0x0da24260
  s_mul_i32 s8, s7, 2560000
  s_add_u32 s8, s8, 4194304
  s_add_u32 s48, s34, s8
  s_addc_u32 s49, s35, 0
  s_mov_b32 s50, 2560000
  s_mov_b32 s51, 0x20000
  s_waitcnt vmcnt(0)
  s_barrier
  ds_read_b64_tr_b16 v[128:129], v6 offset:0
  ds_read_b64_tr_b16 v[192:193], v6 offset:32768
  ds_read_b64_tr_b16 v[130:131], v6 offset:512
  ds_read_b64_tr_b16 v[194:195], v6 offset:33280
  ds_read_b64_tr_b16 v[132:133], v6 offset:2048
  ds_read_b64_tr_b16 v[196:197], v6 offset:34816
  ds_read_b64_tr_b16 v[134:135], v6 offset:2560
  ds_read_b64_tr_b16 v[198:199], v6 offset:35328
  ds_read_b64_tr_b16 v[136:137], v6 offset:4096
  ds_read_b64_tr_b16 v[200:201], v6 offset:36864
  ds_read_b64_tr_b16 v[138:139], v6 offset:4608
  ds_read_b64_tr_b16 v[202:203], v6 offset:37376
  ds_read_b64_tr_b16 v[140:141], v6 offset:6144
  ds_read_b64_tr_b16 v[204:205], v6 offset:38912
  ds_read_b64_tr_b16 v[142:143], v6 offset:6656
  ds_read_b64_tr_b16 v[206:207], v6 offset:39424
  ds_read_b64_tr_b16 v[144:145], v6 offset:8192
  ds_read_b64_tr_b16 v[208:209], v6 offset:40960
  ds_read_b64_tr_b16 v[146:147], v6 offset:8704
  ds_read_b64_tr_b16 v[210:211], v6 offset:41472
  ds_read_b64_tr_b16 v[148:149], v6 offset:10240
  ds_read_b64_tr_b16 v[212:213], v6 offset:43008
  ds_read_b64_tr_b16 v[150:151], v6 offset:10752
  ds_read_b64_tr_b16 v[214:215], v6 offset:43520
  ds_read_b64_tr_b16 v[152:153], v6 offset:12288
  ds_read_b64_tr_b16 v[216:217], v6 offset:45056
  ds_read_b64_tr_b16 v[154:155], v6 offset:12800
  ds_read_b64_tr_b16 v[218:219], v6 offset:45568
  ds_read_b64_tr_b16 v[156:157], v6 offset:14336
  ds_read_b64_tr_b16 v[220:221], v6 offset:47104
  ds_read_b64_tr_b16 v[158:159], v6 offset:14848
  ds_read_b64_tr_b16 v[222:223], v6 offset:47616
  ds_read_b64_tr_b16 v[160:161], v6 offset:16384
  ds_read_b64_tr_b16 v[224:225], v6 offset:49152
  ds_read_b64_tr_b16 v[162:163], v6 offset:16896
  ds_read_b64_tr_b16 v[226:227], v6 offset:49664
  ds_read_b64_tr_b16 v[164:165], v6 offset:18432
  ds_read_b64_tr_b16 v[228:229], v6 offset:51200
  ds_read_b64_tr_b16 v[166:167], v6 offset:18944
  ds_read_b64_tr_b16 v[230:231], v6 offset:51712
  ds_read_b64_tr_b16 v[168:169], v6 offset:20480
  ds_read_b64_tr_b16 v[232:233], v6 offset:53248
  ds_read_b64_tr_b16 v[170:171], v6 offset:20992
  ds_read_b64_tr_b16 v[234:235], v6 offset:53760
  ds_read_b64_tr_b16 v[172:173], v6 offset:22528
  ds_read_b64_tr_b16 v[236:237], v6 offset:55296
  ds_read_b64_tr_b16 v[174:175], v6 offset:23040
  ds_read_b64_tr_b16 v[238:239], v6 offset:55808
  ds_read_b64_tr_b16 v[176:177], v6 offset:24576
  ds_read_b64_tr_b16 v[240:241], v6 offset:57344
  ds_read_b64_tr_b16 v[178:179], v6 offset:25088
  ds_read_b64_tr_b16 v[242:243], v6 offset:57856
  ds_read_b64_tr_b16 v[180:181], v6 offset:26624
  ds_read_b64_tr_b16 v[244:245], v6 offset:59392
  ds_read_b64_tr_b16 v[182:183], v6 offset:27136
  ds_read_b64_tr_b16 v[246:247], v6 offset:59904
  ds_read_b64_tr_b16 v[184:185], v6 offset:28672
  ds_read_b64_tr_b16 v[248:249], v6 offset:61440
  ds_read_b64_tr_b16 v[186:187], v6 offset:29184
  ds_read_b64_tr_b16 v[250:251], v6 offset:61952
  ds_read_b64_tr_b16 v[188:189], v6 offset:30720
  ds_read_b64_tr_b16 v[252:253], v6 offset:63488
  ds_read_b64_tr_b16 v[190:191], v6 offset:31232
  ds_read_b64_tr_b16 v[254:255], v6 offset:64000
  ds_read_b128 v[20:23], v72 offset:0
  ds_read_b128 v[24:27], v73 offset:0
  ds_read_b128 v[28:31], v74 offset:0
  s_setprio 2
  ds_read_b128 v[32:35], v75 offset:0
  s_waitcnt lgkmcnt(3)
  v_mfma_f32_32x32x16_bf16 v[88:103], v[20:23], v[128:131], 0
  v_mfma_f32_32x32x16_bf16 v[104:119], v[20:23], v[192:195], 0
  ds_read_b128 v[20:23], v76 offset:0
  s_waitcnt lgkmcnt(3)
  v_mfma_f32_32x32x16_bf16 v[88:103], v[24:27], v[132:135], v[88:103]
  v_mfma_f32_32x32x16_bf16 v[104:119], v[24:27], v[196:199], v[104:119]
  ds_read_b128 v[24:27], v77 offset:0
  s_waitcnt lgkmcnt(3)
  v_mfma_f32_32x32x16_bf16 v[88:103], v[28:31], v[136:139], v[88:103]
  v_mfma_f32_32x32x16_bf16 v[104:119], v[28:31], v[200:203], v[104:119]
  ds_read_b128 v[28:31], v78 offset:0
  s_waitcnt lgkmcnt(3)
  v_mfma_f32_32x32x16_bf16 v[88:103], v[32:35], v[140:143], v[88:103]
  v_mfma_f32_32x32x16_bf16 v[104:119], v[32:35], v[204:207], v[104:119]
  ds_read_b128 v[32:35], v79 offset:0
  s_waitcnt lgkmcnt(3)
  v_mfma_f32_32x32x16_bf16 v[88:103], v[20:23], v[144:147], v[88:103]
  v_mfma_f32_32x32x16_bf16 v[104:119], v[20:23], v[208:211], v[104:119]
  ds_read_b128 v[20:23], v72 offset:256
  s_waitcnt lgkmcnt(3)
  v_mfma_f32_32x32x16_bf16 v[88:103], v[24:27], v[148:151], v[88:103]
  v_mfma_f32_32x32x16_bf16 v[104:119], v[24:27], v[212:215], v[104:119]
  ds_read_b128 v[24:27], v73 offset:256
  s_waitcnt lgkmcnt(3)
  v_mfma_f32_32x32x16_bf16 v[88:103], v[28:31], v[152:155], v[88:103]
  v_mfma_f32_32x32x16_bf16 v[104:119], v[28:31], v[216:219], v[104:119]
  ds_read_b128 v[28:31], v74 offset:256
  s_waitcnt lgkmcnt(3)
  v_mfma_f32_32x32x16_bf16 v[88:103], v[32:35], v[156:159], v[88:103]
  v_mfma_f32_32x32x16_bf16 v[104:119], v[32:35], v[220:223], v[104:119]
  ds_read_b128 v[32:35], v75 offset:256
  s_waitcnt lgkmcnt(3)
  v_mfma_f32_32x32x16_bf16 v[88:103], v[20:23], v[160:163], v[88:103]
  s_setprio 3
  v_mfma_f32_32x32x16_bf16 v[104:119], v[20:23], v[224:227], v[104:119]
  ds_read_b128 v[20:23], v76 offset:256
  s_waitcnt lgkmcnt(3)
  v_mfma_f32_32x32x16_bf16 v[88:103], v[24:27], v[164:167], v[88:103]
  v_mfma_f32_32x32x16_bf16 v[104:119], v[24:27], v[228:231], v[104:119]
  ds_read_b128 v[24:27], v77 offset:256
  s_waitcnt lgkmcnt(3)
  v_mfma_f32_32x32x16_bf16 v[88:103], v[28:31], v[168:171], v[88:103]
  s_barrier
  v_mfma_f32_32x32x16_bf16 v[104:119], v[28:31], v[232:235], v[104:119]
  ds_read_b128 v[28:31], v78 offset:256
  s_waitcnt lgkmcnt(3)
  v_mfma_f32_32x32x16_bf16 v[88:103], v[32:35], v[172:175], v[88:103]
  v_mfma_f32_32x32x16_bf16 v[104:119], v[32:35], v[236:239], v[104:119]
  ds_read_b128 v[32:35], v79 offset:256
  s_waitcnt lgkmcnt(3)
  v_mfma_f32_32x32x16_bf16 v[88:103], v[20:23], v[176:179], v[88:103]
  v_mfma_f32_32x32x16_bf16 v[104:119], v[20:23], v[240:243], v[104:119]
  s_waitcnt lgkmcnt(2)
  v_mfma_f32_32x32x16_bf16 v[88:103], v[24:27], v[180:183], v[88:103]
  v_mfma_f32_32x32x16_bf16 v[104:119], v[24:27], v[244:247], v[104:119]
  s_waitcnt lgkmcnt(1)
  v_mfma_f32_32x32x16_bf16 v[88:103], v[28:31], v[184:187], v[88:103]
  v_mfma_f32_32x32x16_bf16 v[104:119], v[28:31], v[248:251], v[104:119]
  s_waitcnt lgkmcnt(0)
  v_mfma_f32_32x32x16_bf16 v[88:103], v[32:35], v[188:191], v[88:103]
  v_mfma_f32_32x32x16_bf16 v[104:119], v[32:35], v[252:255], v[104:119]
  s_setprio 0
  v_add_u32 v72, s78, v72
  v_add_u32 v73, s78, v73
  v_add_u32 v74, s78, v74
  v_add_u32 v75, s78, v75
  v_add_u32 v76, s78, v76
  v_add_u32 v77, s78, v77
  v_add_u32 v78, s78, v78
  v_add_u32 v79, s78, v79
  s_lshl_b32 s12, s62, 8
  s_add_u32 s13, s12, 4096
  s_nop 9
  v_rcp_f32 v48, v104
  v_rcp_f32 v49, v105
  v_rcp_f32 v50, v106
  v_rcp_f32 v51, v107
  v_mul_f32 v40, v38, v88
  v_mul_f32 v41, v38, v89
  v_mul_f32 v42, v38, v90
  v_mul_f32 v43, v38, v91
  v_med3_f32 v48, v48, -s10, s10
  v_med3_f32 v49, v49, -s10, s10
  v_med3_f32 v50, v50, -s10, s10
  v_med3_f32 v51, v51, -s10, s10
  v_cvt_pk_bf16_f32 v40, v40, 0
  v_add_u32 v48, 0x8000, v48
  v_cvt_pk_bf16_f32 v41, v41, 0
  v_add_u32 v49, 0x8000, v49
  v_cvt_pk_bf16_f32 v42, v42, 0
  v_add_u32 v50, 0x8000, v50
  v_cvt_pk_bf16_f32 v43, v43, 0
  v_add_u32 v51, 0x8000, v51
  v_sub_u32 v48, v48, v40
  v_sub_u32 v49, v49, v41
  v_sub_u32 v50, v50, v42
  v_sub_u32 v51, v51, v43
  v_and_or_b32 v80, v48, s11, v40
  v_and_or_b32 v81, v49, s11, v41
  v_and_or_b32 v82, v50, s11, v42
  v_and_or_b32 v83, v51, s11, v43
  v_rcp_f32 v52, v108
  v_rcp_f32 v53, v109
  v_rcp_f32 v54, v110
  v_rcp_f32 v55, v111
  v_mul_f32 v44, v38, v92
  v_mul_f32 v45, v38, v93
  v_mul_f32 v46, v38, v94
  v_mul_f32 v47, v38, v95
  v_med3_f32 v52, v52, -s10, s10
  v_med3_f32 v53, v53, -s10, s10
  v_med3_f32 v54, v54, -s10, s10
  v_med3_f32 v55, v55, -s10, s10
  v_cvt_pk_bf16_f32 v44, v44, 0
  v_add_u32 v52, 0x8000, v52
  v_cvt_pk_bf16_f32 v45, v45, 0
  v_add_u32 v53, 0x8000, v53
  v_cvt_pk_bf16_f32 v46, v46, 0
  v_add_u32 v54, 0x8000, v54
  v_cvt_pk_bf16_f32 v47, v47, 0
  v_add_u32 v55, 0x8000, v55
  v_sub_u32 v52, v52, v44
  v_sub_u32 v53, v53, v45
  v_sub_u32 v54, v54, v46
  v_sub_u32 v55, v55, v47
  v_and_or_b32 v84, v52, s11, v44
  v_and_or_b32 v85, v53, s11, v45
  v_and_or_b32 v86, v54, s11, v46
  v_and_or_b32 v87, v55, s11, v47
  v_rcp_f32 v48, v112
  v_rcp_f32 v49, v113
  v_rcp_f32 v50, v114
  v_rcp_f32 v51, v115
  v_mul_f32 v40, v38, v96
  v_mul_f32 v41, v38, v97
  v_mul_f32 v42, v38, v98
  v_mul_f32 v43, v38, v99
  v_med3_f32 v48, v48, -s10, s10
  v_med3_f32 v49, v49, -s10, s10
  v_med3_f32 v50, v50, -s10, s10
  v_med3_f32 v51, v51, -s10, s10
  v_cvt_pk_bf16_f32 v40, v40, 0
  v_add_u32 v48, 0x8000, v48
  v_cvt_pk_bf16_f32 v41, v41, 0
  v_add_u32 v49, 0x8000, v49
  v_cvt_pk_bf16_f32 v42, v42, 0
  v_add_u32 v50, 0x8000, v50
  v_cvt_pk_bf16_f32 v43, v43, 0
  v_add_u32 v51, 0x8000, v51
  v_sub_u32 v48, v48, v40
  v_sub_u32 v49, v49, v41
  v_sub_u32 v50, v50, v42
  v_sub_u32 v51, v51, v43
  v_and_or_b32 v120, v48, s11, v40
  v_and_or_b32 v121, v49, s11, v41
  v_and_or_b32 v122, v50, s11, v42
  v_and_or_b32 v123, v51, s11, v43
  v_rcp_f32 v52, v116
  v_rcp_f32 v53, v117
  v_rcp_f32 v54, v118
  v_rcp_f32 v55, v119
  v_mul_f32 v44, v38, v100
  v_mul_f32 v45, v38, v101
  v_mul_f32 v46, v38, v102
  v_mul_f32 v47, v38, v103
  v_med3_f32 v52, v52, -s10, s10
  v_med3_f32 v53, v53, -s10, s10
  v_med3_f32 v54, v54, -s10, s10
  v_med3_f32 v55, v55, -s10, s10
  v_cvt_pk_bf16_f32 v44, v44, 0
  v_add_u32 v52, 0x8000, v52
  v_cvt_pk_bf16_f32 v45, v45, 0
  v_add_u32 v53, 0x8000, v53
  v_cvt_pk_bf16_f32 v46, v46, 0
  v_add_u32 v54, 0x8000, v54
  v_cvt_pk_bf16_f32 v47, v47, 0
  v_add_u32 v55, 0x8000, v55
  v_sub_u32 v52, v52, v44
  v_sub_u32 v53, v53, v45
  v_sub_u32 v54, v54, v46
  v_sub_u32 v55, v55, v47
  v_and_or_b32 v124, v52, s11, v44
  v_and_or_b32 v125, v53, s11, v45
  v_and_or_b32 v126, v54, s11, v46
  v_and_or_b32 v127, v55, s11, v47
  s_barrier
  v_and_b32 v1, 15, v0
  v_lshlrev_b32 v1, 2, v1
  v_add_u32 v1, 151552, v1
  v_mov_b32 v36, 0
  ds_write_b32 v1, v36
  ds_read_b128 v[20:23], v72 offset:0
  ds_read_b128 v[24:27], v73 offset:0
  ds_read_b128 v[28:31], v74 offset:0
  s_setprio 1
  ds_read_b128 v[32:35], v75 offset:0
  s_waitcnt lgkmcnt(3)
  v_mfma_f32_32x32x16_bf16 v[88:103], v[20:23], v[128:131], 0
  buffer_store_dword v80, v7, s[48:51], s12 offen offset:0 sc1
  v_mfma_f32_32x32x16_bf16 v[104:119], v[20:23], v[192:195], 0
  ds_read_b128 v[20:23], v76 offset:0
  s_waitcnt lgkmcnt(3)
  v_mfma_f32_32x32x16_bf16 v[88:103], v[24:27], v[132:135], v[88:103]
  buffer_store_dword v81, v7, s[48:51], s12 offen offset:256 sc1
  v_mfma_f32_32x32x16_bf16 v[104:119], v[24:27], v[196:199], v[104:119]
  ds_read_b128 v[24:27], v77 offset:0
  s_waitcnt lgkmcnt(3)
  v_mfma_f32_32x32x16_bf16 v[88:103], v[28:31], v[136:139], v[88:103]
  buffer_store_dword v82, v7, s[48:51], s12 offen offset:512 sc1
  v_mfma_f32_32x32x16_bf16 v[104:119], v[28:31], v[200:203], v[104:119]
  ds_read_b128 v[28:31], v78 offset:0
  s_waitcnt lgkmcnt(3)
  v_mfma_f32_32x32x16_bf16 v[88:103], v[32:35], v[140:143], v[88:103]
  buffer_store_dword v83, v7, s[48:51], s12 offen offset:768 sc1
  v_mfma_f32_32x32x16_bf16 v[104:119], v[32:35], v[204:207], v[104:119]
  ds_read_b128 v[32:35], v79 offset:0
  s_waitcnt lgkmcnt(3)
  v_mfma_f32_32x32x16_bf16 v[88:103], v[20:23], v[144:147], v[88:103]
  buffer_store_dword v84, v7, s[48:51], s12 offen offset:2048 sc1
  v_mfma_f32_32x32x16_bf16 v[104:119], v[20:23], v[208:211], v[104:119]
  ds_read_b128 v[20:23], v72 offset:256
  s_waitcnt lgkmcnt(3)
  v_mfma_f32_32x32x16_bf16 v[88:103], v[24:27], v[148:151], v[88:103]
  buffer_store_dword v85, v7, s[48:51], s12 offen offset:2304 sc1
  v_mfma_f32_32x32x16_bf16 v[104:119], v[24:27], v[212:215], v[104:119]
  ds_read_b128 v[24:27], v73 offset:256
  s_waitcnt lgkmcnt(3)
  v_mfma_f32_32x32x16_bf16 v[88:103], v[28:31], v[152:155], v[88:103]
  buffer_store_dword v86, v7, s[48:51], s12 offen offset:2560 sc1
  v_mfma_f32_32x32x16_bf16 v[104:119], v[28:31], v[216:219], v[104:119]
  ds_read_b128 v[28:31], v74 offset:256
  s_waitcnt lgkmcnt(3)
  v_mfma_f32_32x32x16_bf16 v[88:103], v[32:35], v[156:159], v[88:103]
  buffer_store_dword v87, v7, s[48:51], s12 offen offset:2816 sc1
  v_mfma_f32_32x32x16_bf16 v[104:119], v[32:35], v[220:223], v[104:119]
  ds_read_b128 v[32:35], v75 offset:256
  s_waitcnt lgkmcnt(3)
  v_mfma_f32_32x32x16_bf16 v[88:103], v[20:23], v[160:163], v[88:103]
  buffer_store_dword v120, v7, s[48:51], s13 offen offset:0 sc1
  s_setprio 3
  v_mfma_f32_32x32x16_bf16 v[104:119], v[20:23], v[224:227], v[104:119]
  ds_read_b128 v[20:23], v76 offset:256
  s_waitcnt lgkmcnt(3)
  v_mfma_f32_32x32x16_bf16 v[88:103], v[24:27], v[164:167], v[88:103]
  buffer_store_dword v121, v7, s[48:51], s13 offen offset:256 sc1
  v_mfma_f32_32x32x16_bf16 v[104:119], v[24:27], v[228:231], v[104:119]
  ds_read_b128 v[24:27], v77 offset:256
  s_waitcnt lgkmcnt(3)
  v_mfma_f32_32x32x16_bf16 v[88:103], v[28:31], v[168:171], v[88:103]
  buffer_store_dword v122, v7, s[48:51], s13 offen offset:512 sc1
  v_mfma_f32_32x32x16_bf16 v[104:119], v[28:31], v[232:235], v[104:119]
  ds_read_b128 v[28:31], v78 offset:256
  s_waitcnt lgkmcnt(3)
  v_mfma_f32_32x32x16_bf16 v[88:103], v[32:35], v[172:175], v[88:103]
  buffer_store_dword v123, v7, s[48:51], s13 offen offset:768 sc1
  v_mfma_f32_32x32x16_bf16 v[104:119], v[32:35], v[236:239], v[104:119]
  ds_read_b128 v[32:35], v79 offset:256
  s_waitcnt lgkmcnt(3)
  v_mfma_f32_32x32x16_bf16 v[88:103], v[20:23], v[176:179], v[88:103]
  buffer_store_dword v124, v7, s[48:51], s13 offen offset:2048 sc1
  v_mfma_f32_32x32x16_bf16 v[104:119], v[20:23], v[240:243], v[104:119]
  s_waitcnt lgkmcnt(2)
  v_mfma_f32_32x32x16_bf16 v[88:103], v[24:27], v[180:183], v[88:103]
  buffer_store_dword v125, v7, s[48:51], s13 offen offset:2304 sc1
  v_mfma_f32_32x32x16_bf16 v[104:119], v[24:27], v[244:247], v[104:119]
  s_waitcnt lgkmcnt(1)
  v_mfma_f32_32x32x16_bf16 v[88:103], v[28:31], v[184:187], v[88:103]
  buffer_store_dword v126, v7, s[48:51], s13 offen offset:2560 sc1
  v_mfma_f32_32x32x16_bf16 v[104:119], v[28:31], v[248:251], v[104:119]
  s_waitcnt lgkmcnt(0)
  v_mfma_f32_32x32x16_bf16 v[88:103], v[32:35], v[188:191], v[88:103]
  buffer_store_dword v127, v7, s[48:51], s13 offen offset:2816 sc1
  v_mfma_f32_32x32x16_bf16 v[104:119], v[32:35], v[252:255], v[104:119]
  s_setprio 0
  s_barrier
  v_mov_b32 v58, 0
  global_load_dwordx2 v[58:59], v58, s[32:33] offset:128 sc1
  s_mov_b32 s85, 1
  s_bitcmp1_b32 s4, 0
  s_cselect_b32 s76, s63, s62
  s_cselect_b32 s77, s65, s64
  s_mul_i32 s79, s7, 2560000
  s_add_u32 s79, s79, 4194304
  s_lshl_b32 s76, s76, 8
  s_lshl_b32 s77, s77, 8
  s_add_u32 s76, s76, s79
  s_add_u32 s77, s77, s79
  v_lshlrev_b32 v61, 7, v2
  v_add_u32 v60, s76, v61
  v_add_u32 v61, s77, v61
  s_lshl_b32 s12, s64, 8
  s_add_u32 s13, s12, 4096
  s_nop 9
  v_rcp_f32 v48, v104
  v_rcp_f32 v49, v105
  v_rcp_f32 v50, v106
  v_rcp_f32 v51, v107
  v_mul_f32 v40, v38, v88
  v_mul_f32 v41, v38, v89
  v_mul_f32 v42, v38, v90
  v_mul_f32 v43, v38, v91
  v_med3_f32 v48, v48, -s10, s10
  v_med3_f32 v49, v49, -s10, s10
  v_med3_f32 v50, v50, -s10, s10
  v_med3_f32 v51, v51, -s10, s10
  v_cvt_pk_bf16_f32 v40, v40, 0
  v_add_u32 v48, 0x8000, v48
  v_cvt_pk_bf16_f32 v41, v41, 0
  v_add_u32 v49, 0x8000, v49
  v_cvt_pk_bf16_f32 v42, v42, 0
  v_add_u32 v50, 0x8000, v50
  v_cvt_pk_bf16_f32 v43, v43, 0
  v_add_u32 v51, 0x8000, v51
  v_sub_u32 v48, v48, v40
  v_sub_u32 v49, v49, v41
  v_sub_u32 v50, v50, v42
  v_sub_u32 v51, v51, v43
  v_and_or_b32 v48, v48, s11, v40
  v_and_or_b32 v49, v49, s11, v41
  v_and_or_b32 v50, v50, s11, v42
  v_and_or_b32 v51, v51, s11, v43
  buffer_store_dword v48, v7, s[48:51], s12 offen offset:0 sc1
  buffer_store_dword v49, v7, s[48:51], s12 offen offset:256 sc1
  buffer_store_dword v50, v7, s[48:51], s12 offen offset:512 sc1
  buffer_store_dword v51, v7, s[48:51], s12 offen offset:768 sc1
  v_rcp_f32 v52, v108
  v_rcp_f32 v53, v109
  v_rcp_f32 v54, v110
  v_rcp_f32 v55, v111
  v_mul_f32 v44, v38, v92
  v_mul_f32 v45, v38, v93
  v_mul_f32 v46, v38, v94
  v_mul_f32 v47, v38, v95
  v_med3_f32 v52, v52, -s10, s10
  v_med3_f32 v53, v53, -s10, s10
  v_med3_f32 v54, v54, -s10, s10
  v_med3_f32 v55, v55, -s10, s10
  v_cvt_pk_bf16_f32 v44, v44, 0
  v_add_u32 v52, 0x8000, v52
  v_cvt_pk_bf16_f32 v45, v45, 0
  v_add_u32 v53, 0x8000, v53
  v_cvt_pk_bf16_f32 v46, v46, 0
  v_add_u32 v54, 0x8000, v54
  v_cvt_pk_bf16_f32 v47, v47, 0
  v_add_u32 v55, 0x8000, v55
  v_sub_u32 v52, v52, v44
  v_sub_u32 v53, v53, v45
  v_sub_u32 v54, v54, v46
  v_sub_u32 v55, v55, v47
  v_and_or_b32 v52, v52, s11, v44
  v_and_or_b32 v53, v53, s11, v45
  v_and_or_b32 v54, v54, s11, v46
  v_and_or_b32 v55, v55, s11, v47
  buffer_store_dword v52, v7, s[48:51], s12 offen offset:2048 sc1
  buffer_store_dword v53, v7, s[48:51], s12 offen offset:2304 sc1
  buffer_store_dword v54, v7, s[48:51], s12 offen offset:2560 sc1
  buffer_store_dword v55, v7, s[48:51], s12 offen offset:2816 sc1
  v_rcp_f32 v48, v112
  v_rcp_f32 v49, v113
  v_rcp_f32 v50, v114
  v_rcp_f32 v51, v115
  v_mul_f32 v40, v38, v96
  v_mul_f32 v41, v38, v97
  v_mul_f32 v42, v38, v98
  v_mul_f32 v43, v38, v99
  v_med3_f32 v48, v48, -s10, s10
  v_med3_f32 v49, v49, -s10, s10
  v_med3_f32 v50, v50, -s10, s10
  v_med3_f32 v51, v51, -s10, s10
  v_cvt_pk_bf16_f32 v40, v40, 0
  v_add_u32 v48, 0x8000, v48
  v_cvt_pk_bf16_f32 v41, v41, 0
  v_add_u32 v49, 0x8000, v49
  v_cvt_pk_bf16_f32 v42, v42, 0
  v_add_u32 v50, 0x8000, v50
  v_cvt_pk_bf16_f32 v43, v43, 0
  v_add_u32 v51, 0x8000, v51
  v_sub_u32 v48, v48, v40
  v_sub_u32 v49, v49, v41
  v_sub_u32 v50, v50, v42
  v_sub_u32 v51, v51, v43
  v_and_or_b32 v48, v48, s11, v40
  v_and_or_b32 v49, v49, s11, v41
  v_and_or_b32 v50, v50, s11, v42
  v_and_or_b32 v51, v51, s11, v43
  buffer_store_dword v48, v7, s[48:51], s13 offen offset:0 sc1
  buffer_store_dword v49, v7, s[48:51], s13 offen offset:256 sc1
  buffer_store_dword v50, v7, s[48:51], s13 offen offset:512 sc1
  buffer_store_dword v51, v7, s[48:51], s13 offen offset:768 sc1
  v_rcp_f32 v52, v116
  v_rcp_f32 v53, v117
  v_rcp_f32 v54, v118
  v_rcp_f32 v55, v119
  v_mul_f32 v44, v38, v100
  v_mul_f32 v45, v38, v101
  v_mul_f32 v46, v38, v102
  v_mul_f32 v47, v38, v103
  v_med3_f32 v52, v52, -s10, s10
  v_med3_f32 v53, v53, -s10, s10
  v_med3_f32 v54, v54, -s10, s10
  v_med3_f32 v55, v55, -s10, s10
  v_cvt_pk_bf16_f32 v44, v44, 0
  v_add_u32 v52, 0x8000, v52
  v_cvt_pk_bf16_f32 v45, v45, 0
  v_add_u32 v53, 0x8000, v53
  v_cvt_pk_bf16_f32 v46, v46, 0
  v_add_u32 v54, 0x8000, v54
  v_cvt_pk_bf16_f32 v47, v47, 0
  v_add_u32 v55, 0x8000, v55
  v_sub_u32 v52, v52, v44
  v_sub_u32 v53, v53, v45
  v_sub_u32 v54, v54, v46
  v_sub_u32 v55, v55, v47
  v_and_or_b32 v52, v52, s11, v44
  v_and_or_b32 v53, v53, s11, v45
  v_and_or_b32 v54, v54, s11, v46
  v_and_or_b32 v55, v55, s11, v47
  buffer_store_dword v52, v7, s[48:51], s13 offen offset:2048 sc1
  buffer_store_dword v53, v7, s[48:51], s13 offen offset:2304 sc1
  buffer_store_dword v54, v7, s[48:51], s13 offen offset:2560 sc1
  buffer_store_dword v55, v7, s[48:51], s13 offen offset:2816 sc1
  s_bfe_u32 s66, s4, 0x10001
  s_mul_i32 s66, s66, 20
  s_add_u32 s66, s66, s59
  s_and_b32 s67, s4, 1
  s_add_u32 s3, s7, 4
  s_branch K1_FIN
K1_HI:
  s_add_u32 s8, s7, s61
  s_add_u32 s8, s8, 1
  s_cmp_ge_u32 s8, 5
  s_cselect_b32 s9, 5, 0
  s_sub_u32 s8, s8, s9
  s_lshl_b32 s67, s8, 14
  s_add_u32 s67, s67, 65536
  s_lshl_b32 s63, s8, 5
  s_add_u32 s63, s63, s5
  s_add_u32 s8, s7, s61
  s_add_u32 s8, s8, 3
  s_cmp_ge_u32 s8, 5
  s_cselect_b32 s9, 5, 0
  s_sub_u32 s8, s8, s9
  s_lshl_b32 s68, s8, 14
  s_add_u32 s68, s68, 65536
  s_lshl_b32 s64, s8, 5
  s_add_u32 s64, s64, s5
  s_add_u32 s8, s7, s61
  s_add_u32 s8, s8, 1
  s_cmp_ge_u32 s8, 3
  s_cselect_b32 s9, 3, 0
  s_sub_u32 s8, s8, s9
  s_mul_i32 s9, s59, 3
  s_add_u32 s8, s8, s9
  s_mul_i32 s9, s8, 52
  s_lshr_b32 s9, s9, 8
  s_mul_i32 s71, s9, 5
  s_sub_u32 s71, s8, s71
  s_lshl_b32 s71, s71, 5
  s_add_u32 s9, s9, s70
  s_mul_i32 s65, s9, 5000
  s_add_u32 s65, s65, 63
  s_lshr_b32 s65, s65, 6
  s_lshl_b32 s65, s65, 1
  s_add_u32 s65, s65, s71
  s_lshl_b32 s69, s61, 14
  s_mov_b32 s10, 0x7f000000
  s_mov_b32 s11, 0xffff0000
  v_and_b32 v5, 15, v3
  v_xor_b32 v5, v5, v4
  v_lshlrev_b32 v5, 4, v5
  v_lshl_add_u32 v5, v3, 9, v5
  v_add_u32 v5, s67, v5
  s_sub_u32 s78, s69, s67
  v_xor_b32 v72, 0, v5
  v_xor_b32 v73, 32, v5
  v_xor_b32 v74, 64, v5
  v_xor_b32 v75, 96, v5
  v_xor_b32 v76, 128, v5
  v_xor_b32 v77, 160, v5
  v_xor_b32 v78, 192, v5
  v_xor_b32 v79, 224, v5
  v_bfe_u32 v6, v2, 2, 2
  v_lshl_add_u32 v7, v4, 3, v6
  v_lshlrev_b32 v7, 7, v7
  v_lshrrev_b32 v6, 1, v6
  v_lshl_add_u32 v7, v6, 6, v7
  v_bfe_u32 v6, v2, 4, 1
  v_lshl_add_u32 v7, v6, 5, v7
  v_and_b32 v6, 3, v2
  v_lshl_add_u32 v7, v6, 3, v7
  s_and_b32 s8, s4, 1
  s_lshl_b32 s9, s8, 6
  v_xor_b32 v6, s9, v7
  v_lshlrev_b32 v7, 10, v4
  v_lshl_add_u32 v7, v3, 2, v7
  s_lshl_b32 s8, s8, 7
  v_add_u32 v7, s8, v7
  v_mov_b32 v38, 0xbfb8aa3b
  v_mov_b32 v39, 0x0da24260
  s_mul_i32 s8, s7, 2560000
  s_add_u32 s8, s8, 4194304
  s_add_u32 s48, s34, s8
  s_addc_u32 s49, s35, 0
  s_mov_b32 s50, 2560000
  s_mov_b32 s51, 0x20000
  s_lshl_b32 s57, s63, 9
  s_add_u32 s57, s57, s56
  s_add_u32 s58, s67, s56
  s_add_u32 m0, s58, 0
  s_nop 0
  buffer_load_dwordx4 v12, s[36:39], s57 offen lds
  s_add_u32 m0, s58, 1024
  s_nop 0
  buffer_load_dwordx4 v13, s[36:39], s57 offen lds
  s_add_u32 m0, s58, 2048
  s_nop 0
  buffer_load_dwordx4 v14, s[36:39], s57 offen lds
  s_add_u32 m0, s58, 3072
  s_nop 0
  buffer_load_dwordx4 v15, s[36:39], s57 offen lds
  s_add_u32 m0, s58, 4096
  s_nop 0
  buffer_load_dwordx4 v16, s[36:39], s57 offen lds
  s_add_u32 m0, s58, 5120
  s_nop 0
  buffer_load_dwordx4 v17, s[36:39], s57 offen lds
  s_add_u32 m0, s58, 6144
  s_nop 0
  buffer_load_dwordx4 v18, s[36:39], s57 offen lds
  s_add_u32 m0, s58, 7168
  s_nop 0
  buffer_load_dwordx4 v19, s[36:39], s57 offen lds
  s_waitcnt vmcnt(8)
  s_barrier
  s_lshl_b32 s57, s64, 9
  s_add_u32 s57, s57, s56
  s_add_u32 s58, s68, s56
  s_add_u32 m0, s58, 0
  s_nop 0
  buffer_load_dwordx4 v12, s[36:39], s57 offen lds
  ds_read_b64_tr_b16 v[128:129], v6 offset:0
  ds_read_b64_tr_b16 v[192:193], v6 offset:32768
  ds_read_b64_tr_b16 v[130:131], v6 offset:512
  ds_read_b64_tr_b16 v[194:195], v6 offset:33280
  ds_read_b64_tr_b16 v[132:133], v6 offset:2048
  ds_read_b64_tr_b16 v[196:197], v6 offset:34816
  ds_read_b64_tr_b16 v[134:135], v6 offset:2560
  ds_read_b64_tr_b16 v[198:199], v6 offset:35328
  s_add_u32 m0, s58, 1024
  s_nop 0
  buffer_load_dwordx4 v13, s[36:39], s57 offen lds
  ds_read_b64_tr_b16 v[136:137], v6 offset:4096
  ds_read_b64_tr_b16 v[200:201], v6 offset:36864
  ds_read_b64_tr_b16 v[138:139], v6 offset:4608
  ds_read_b64_tr_b16 v[202:203], v6 offset:37376
  ds_read_b64_tr_b16 v[140:141], v6 offset:6144
  ds_read_b64_tr_b16 v[204:205], v6 offset:38912
  ds_read_b64_tr_b16 v[142:143], v6 offset:6656
  ds_read_b64_tr_b16 v[206:207], v6 offset:39424
  s_add_u32 m0, s58, 2048
  s_nop 0
  buffer_load_dwordx4 v14, s[36:39], s57 offen lds
  ds_read_b64_tr_b16 v[144:145], v6 offset:8192
  ds_read_b64_tr_b16 v[208:209], v6 offset:40960
  ds_read_b64_tr_b16 v[146:147], v6 offset:8704
  ds_read_b64_tr_b16 v[210:211], v6 offset:41472
  ds_read_b64_tr_b16 v[148:149], v6 offset:10240
  ds_read_b64_tr_b16 v[212:213], v6 offset:43008
  ds_read_b64_tr_b16 v[150:151], v6 offset:10752
  ds_read_b64_tr_b16 v[214:215], v6 offset:43520
  s_add_u32 m0, s58, 3072
  s_nop 0
  buffer_load_dwordx4 v15, s[36:39], s57 offen lds
  ds_read_b64_tr_b16 v[152:153], v6 offset:12288
  ds_read_b64_tr_b16 v[216:217], v6 offset:45056
  ds_read_b64_tr_b16 v[154:155], v6 offset:12800
  ds_read_b64_tr_b16 v[218:219], v6 offset:45568
  ds_read_b64_tr_b16 v[156:157], v6 offset:14336
  ds_read_b64_tr_b16 v[220:221], v6 offset:47104
  ds_read_b64_tr_b16 v[158:159], v6 offset:14848
  ds_read_b64_tr_b16 v[222:223], v6 offset:47616
  s_add_u32 m0, s58, 4096
  s_nop 0
  buffer_load_dwordx4 v16, s[36:39], s57 offen lds
  ds_read_b64_tr_b16 v[160:161], v6 offset:16384
  ds_read_b64_tr_b16 v[224:225], v6 offset:49152
  ds_read_b64_tr_b16 v[162:163], v6 offset:16896
  ds_read_b64_tr_b16 v[226:227], v6 offset:49664
  ds_read_b64_tr_b16 v[164:165], v6 offset:18432
  ds_read_b64_tr_b16 v[228:229], v6 offset:51200
  ds_read_b64_tr_b16 v[166:167], v6 offset:18944
  ds_read_b64_tr_b16 v[230:231], v6 offset:51712
  s_add_u32 m0, s58, 5120
  s_nop 0
  buffer_load_dwordx4 v17, s[36:39], s57 offen lds
  ds_read_b64_tr_b16 v[168:169], v6 offset:20480
  ds_read_b64_tr_b16 v[232:233], v6 offset:53248
  ds_read_b64_tr_b16 v[170:171], v6 offset:20992
  ds_read_b64_tr_b16 v[234:235], v6 offset:53760
  ds_read_b64_tr_b16 v[172:173], v6 offset:22528
  ds_read_b64_tr_b16 v[236:237], v6 offset:55296
  ds_read_b64_tr_b16 v[174:175], v6 offset:23040
  ds_read_b64_tr_b16 v[238:239], v6 offset:55808
  s_add_u32 m0, s58, 6144
  s_nop 0
  buffer_load_dwordx4 v18, s[36:39], s57 offen lds
  ds_read_b64_tr_b16 v[176:177], v6 offset:24576
  ds_read_b64_tr_b16 v[240:241], v6 offset:57344
  ds_read_b64_tr_b16 v[178:179], v6 offset:25088
  ds_read_b64_tr_b16 v[242:243], v6 offset:57856
  ds_read_b64_tr_b16 v[180:181], v6 offset:26624
  ds_read_b64_tr_b16 v[244:245], v6 offset:59392
  ds_read_b64_tr_b16 v[182:183], v6 offset:27136
  ds_read_b64_tr_b16 v[246:247], v6 offset:59904
  s_add_u32 m0, s58, 7168
  s_nop 0
  buffer_load_dwordx4 v19, s[36:39], s57 offen lds
  ds_read_b64_tr_b16 v[184:185], v6 offset:28672
  ds_read_b64_tr_b16 v[248:249], v6 offset:61440
  ds_read_b64_tr_b16 v[186:187], v6 offset:29184
  ds_read_b64_tr_b16 v[250:251], v6 offset:61952
  ds_read_b64_tr_b16 v[188:189], v6 offset:30720
  ds_read_b64_tr_b16 v[252:253], v6 offset:63488
  ds_read_b64_tr_b16 v[190:191], v6 offset:31232
  ds_read_b64_tr_b16 v[254:255], v6 offset:64000
  s_waitcnt vmcnt(8) lgkmcnt(0)
  s_barrier
  s_lshl_b32 s57, s65, 9
  s_add_u32 s57, s57, s56
  s_add_u32 s58, s69, s56
  s_add_u32 m0, s58, 0
  s_nop 0
  buffer_load_dwordx4 v12, s[36:39], s57 offen lds
  s_add_u32 m0, s58, 1024
  s_nop 0
  buffer_load_dwordx4 v13, s[36:39], s57 offen lds
  s_add_u32 m0, s58, 2048
  s_nop 0
  buffer_load_dwordx4 v14, s[36:39], s57 offen lds
  s_add_u32 m0, s58, 3072
  s_nop 0
  buffer_load_dwordx4 v15, s[36:39], s57 offen lds
  s_add_u32 m0, s58, 4096
  s_nop 0
  buffer_load_dwordx4 v16, s[36:39], s57 offen lds
  s_add_u32 m0, s58, 5120
  s_nop 0
  buffer_load_dwordx4 v17, s[36:39], s57 offen lds
  s_add_u32 m0, s58, 6144
  s_nop 0
  buffer_load_dwordx4 v18, s[36:39], s57 offen lds
  s_add_u32 m0, s58, 7168
  s_nop 0
  buffer_load_dwordx4 v19, s[36:39], s57 offen lds
  ds_read_b128 v[20:23], v72 offset:0
  ds_read_b128 v[24:27], v73 offset:0
  ds_read_b128 v[28:31], v74 offset:0
  s_setprio 1
  ds_read_b128 v[32:35], v75 offset:0
  s_waitcnt lgkmcnt(3)
  v_mfma_f32_32x32x16_bf16 v[88:103], v[20:23], v[128:131], 0
  v_mfma_f32_32x32x16_bf16 v[104:119], v[20:23], v[192:195], 0
  ds_read_b128 v[20:23], v76 offset:0
  s_waitcnt lgkmcnt(3)
  v_mfma_f32_32x32x16_bf16 v[88:103], v[24:27], v[132:135], v[88:103]
  v_mfma_f32_32x32x16_bf16 v[104:119], v[24:27], v[196:199], v[104:119]
  ds_read_b128 v[24:27], v77 offset:0
  s_waitcnt lgkmcnt(3)
  v_mfma_f32_32x32x16_bf16 v[88:103], v[28:31], v[136:139], v[88:103]
  v_mfma_f32_32x32x16_bf16 v[104:119], v[28:31], v[200:203], v[104:119]
  ds_read_b128 v[28:31], v78 offset:0
  s_waitcnt lgkmcnt(3)
  v_mfma_f32_32x32x16_bf16 v[88:103], v[32:35], v[140:143], v[88:103]
  v_mfma_f32_32x32x16_bf16 v[104:119], v[32:35], v[204:207], v[104:119]
  ds_read_b128 v[32:35], v79 offset:0
  s_waitcnt lgkmcnt(3)
  v_mfma_f32_32x32x16_bf16 v[88:103], v[20:23], v[144:147], v[88:103]
  v_mfma_f32_32x32x16_bf16 v[104:119], v[20:23], v[208:211], v[104:119]
  ds_read_b128 v[20:23], v72 offset:256
  s_waitcnt lgkmcnt(3)
  v_mfma_f32_32x32x16_bf16 v[88:103], v[24:27], v[148:151], v[88:103]
  v_mfma_f32_32x32x16_bf16 v[104:119], v[24:27], v[212:215], v[104:119]
  ds_read_b128 v[24:27], v73 offset:256
  s_waitcnt lgkmcnt(3)
  v_mfma_f32_32x32x16_bf16 v[88:103], v[28:31], v[152:155], v[88:103]
  v_mfma_f32_32x32x16_bf16 v[104:119], v[28:31], v[216:219], v[104:119]
  ds_read_b128 v[28:31], v74 offset:256
  s_waitcnt lgkmcnt(3)
  v_mfma_f32_32x32x16_bf16 v[88:103], v[32:35], v[156:159], v[88:103]
  v_mfma_f32_32x32x16_bf16 v[104:119], v[32:35], v[220:223], v[104:119]
  ds_read_b128 v[32:35], v75 offset:256
  s_waitcnt lgkmcnt(3)
  v_mfma_f32_32x32x16_bf16 v[88:103], v[20:23], v[160:163], v[88:103]
  s_setprio 3
  v_mfma_f32_32x32x16_bf16 v[104:119], v[20:23], v[224:227], v[104:119]
  ds_read_b128 v[20:23], v76 offset:256
  s_waitcnt lgkmcnt(3)
  v_mfma_f32_32x32x16_bf16 v[88:103], v[24:27], v[164:167], v[88:103]
  v_mfma_f32_32x32x16_bf16 v[104:119], v[24:27], v[228:231], v[104:119]
  ds_read_b128 v[24:27], v77 offset:256
  s_waitcnt lgkmcnt(3)
  v_mfma_f32_32x32x16_bf16 v[88:103], v[28:31], v[168:171], v[88:103]
  v_mfma_f32_32x32x16_bf16 v[104:119], v[28:31], v[232:235], v[104:119]
  ds_read_b128 v[28:31], v78 offset:256
  s_waitcnt lgkmcnt(3)
  v_mfma_f32_32x32x16_bf16 v[88:103], v[32:35], v[172:175], v[88:103]
  v_mfma_f32_32x32x16_bf16 v[104:119], v[32:35], v[236:239], v[104:119]
  ds_read_b128 v[32:35], v79 offset:256
  s_waitcnt lgkmcnt(3)
  v_mfma_f32_32x32x16_bf16 v[88:103], v[20:23], v[176:179], v[88:103]
  v_mfma_f32_32x32x16_bf16 v[104:119], v[20:23], v[240:243], v[104:119]
  s_waitcnt lgkmcnt(2)
  v_mfma_f32_32x32x16_bf16 v[88:103], v[24:27], v[180:183], v[88:103]
  s_waitcnt vmcnt(8)
  s_barrier
  v_mfma_f32_32x32x16_bf16 v[104:119], v[24:27], v[244:247], v[104:119]
  s_waitcnt lgkmcnt(1)
  v_mfma_f32_32x32x16_bf16 v[88:103], v[28:31], v[184:187], v[88:103]
  v_mfma_f32_32x32x16_bf16 v[104:119], v[28:31], v[248:251], v[104:119]
  s_waitcnt lgkmcnt(0)
  v_mfma_f32_32x32x16_bf16 v[88:103], v[32:35], v[188:191], v[88:103]
  v_mfma_f32_32x32x16_bf16 v[104:119], v[32:35], v[252:255], v[104:119]
  s_setprio 0
  v_add_u32 v72, s78, v72
  v_add_u32 v73, s78, v73
  v_add_u32 v74, s78, v74
  v_add_u32 v75, s78, v75
  v_add_u32 v76, s78, v76
  v_add_u32 v77, s78, v77
  v_add_u32 v78, s78, v78
  v_add_u32 v79, s78, v79
  s_lshl_b32 s12, s63, 8
  s_add_u32 s13, s12, 4096
  s_nop 9
  v_rcp_f32 v48, v104
  v_rcp_f32 v49, v105
  v_rcp_f32 v50, v106
  v_rcp_f32 v51, v107
  v_mul_f32 v40, v38, v88
  v_mul_f32 v41, v38, v89
  v_mul_f32 v42, v38, v90
  v_mul_f32 v43, v38, v91
  v_med3_f32 v48, v48, -s10, s10
  v_med3_f32 v49, v49, -s10, s10
  v_med3_f32 v50, v50, -s10, s10
  v_med3_f32 v51, v51, -s10, s10
  v_cvt_pk_bf16_f32 v40, v40, 0
  v_add_u32 v48, 0x8000, v48
  v_cvt_pk_bf16_f32 v41, v41, 0
  v_add_u32 v49, 0x8000, v49
  v_cvt_pk_bf16_f32 v42, v42, 0
  v_add_u32 v50, 0x8000, v50
  v_cvt_pk_bf16_f32 v43, v43, 0
  v_add_u32 v51, 0x8000, v51
  v_sub_u32 v48, v48, v40
  v_sub_u32 v49, v49, v41
  v_sub_u32 v50, v50, v42
  v_sub_u32 v51, v51, v43
  v_and_or_b32 v48, v48, s11, v40
  v_and_or_b32 v49, v49, s11, v41
  v_and_or_b32 v50, v50, s11, v42
  v_and_or_b32 v51, v51, s11, v43
  buffer_store_dword v48, v7, s[48:51], s12 offen offset:0 sc1
  buffer_store_dword v49, v7, s[48:51], s12 offen offset:256 sc1
  buffer_store_dword v50, v7, s[48:51], s12 offen offset:512 sc1
  buffer_store_dword v51, v7, s[48:51], s12 offen offset:768 sc1
  v_rcp_f32 v52, v108
  v_rcp_f32 v53, v109
  v_rcp_f32 v54, v110
  v_rcp_f32 v55, v111
  v_mul_f32 v44, v38, v92
  v_mul_f32 v45, v38, v93
  v_mul_f32 v46, v38, v94
  v_mul_f32 v47, v38, v95
  v_med3_f32 v52, v52, -s10, s10
  v_med3_f32 v53, v53, -s10, s10
  v_med3_f32 v54, v54, -s10, s10
  v_med3_f32 v55, v55, -s10, s10
  v_cvt_pk_bf16_f32 v44, v44, 0
  v_add_u32 v52, 0x8000, v52
  v_cvt_pk_bf16_f32 v45, v45, 0
  v_add_u32 v53, 0x8000, v53
  v_cvt_pk_bf16_f32 v46, v46, 0
  v_add_u32 v54, 0x8000, v54
  v_cvt_pk_bf16_f32 v47, v47, 0
  v_add_u32 v55, 0x8000, v55
  v_sub_u32 v52, v52, v44
  v_sub_u32 v53, v53, v45
  v_sub_u32 v54, v54, v46
  v_sub_u32 v55, v55, v47
  v_and_or_b32 v52, v52, s11, v44
  v_and_or_b32 v53, v53, s11, v45
  v_and_or_b32 v54, v54, s11, v46
  v_and_or_b32 v55, v55, s11, v47
  buffer_store_dword v52, v7, s[48:51], s12 offen offset:2048 sc1
  buffer_store_dword v53, v7, s[48:51], s12 offen offset:2304 sc1
  buffer_store_dword v54, v7, s[48:51], s12 offen offset:2560 sc1
  buffer_store_dword v55, v7, s[48:51], s12 offen offset:2816 sc1
  v_rcp_f32 v48, v112
  v_rcp_f32 v49, v113
  v_rcp_f32 v50, v114
  v_rcp_f32 v51, v115
  v_mul_f32 v40, v38, v96
  v_mul_f32 v41, v38, v97
  v_mul_f32 v42, v38, v98
  v_mul_f32 v43, v38, v99
  v_med3_f32 v48, v48, -s10, s10
  v_med3_f32 v49, v49, -s10, s10
  v_med3_f32 v50, v50, -s10, s10
  v_med3_f32 v51, v51, -s10, s10
  v_cvt_pk_bf16_f32 v40, v40, 0
  v_add_u32 v48, 0x8000, v48
  v_cvt_pk_bf16_f32 v41, v41, 0
  v_add_u32 v49, 0x8000, v49
  v_cvt_pk_bf16_f32 v42, v42, 0
  v_add_u32 v50, 0x8000, v50
  v_cvt_pk_bf16_f32 v43, v43, 0
  v_add_u32 v51, 0x8000, v51
  v_sub_u32 v48, v48, v40
  v_sub_u32 v49, v49, v41
  v_sub_u32 v50, v50, v42
  v_sub_u32 v51, v51, v43
  v_and_or_b32 v48, v48, s11, v40
  v_and_or_b32 v49, v49, s11, v41
  v_and_or_b32 v50, v50, s11, v42
  v_and_or_b32 v51, v51, s11, v43
  buffer_store_dword v48, v7, s[48:51], s13 offen offset:0 sc1
  buffer_store_dword v49, v7, s[48:51], s13 offen offset:256 sc1
  buffer_store_dword v50, v7, s[48:51], s13 offen offset:512 sc1
  buffer_store_dword v51, v7, s[48:51], s13 offen offset:768 sc1
  v_rcp_f32 v52, v116
  v_rcp_f32 v53, v117
  v_rcp_f32 v54, v118
  v_rcp_f32 v55, v119
  v_mul_f32 v44, v38, v100
  v_mul_f32 v45, v38, v101
  v_mul_f32 v46, v38, v102
  v_mul_f32 v47, v38, v103
  v_med3_f32 v52, v52, -s10, s10
  v_med3_f32 v53, v53, -s10, s10
  v_med3_f32 v54, v54, -s10, s10
  v_med3_f32 v55, v55, -s10, s10
  v_cvt_pk_bf16_f32 v44, v44, 0
  v_add_u32 v52, 0x8000, v52
  v_cvt_pk_bf16_f32 v45, v45, 0
  v_add_u32 v53, 0x8000, v53
  v_cvt_pk_bf16_f32 v46, v46, 0
  v_add_u32 v54, 0x8000, v54
  v_cvt_pk_bf16_f32 v47, v47, 0
  v_add_u32 v55, 0x8000, v55
  v_sub_u32 v52, v52, v44
  v_sub_u32 v53, v53, v45
  v_sub_u32 v54, v54, v46
  v_sub_u32 v55, v55, v47
  v_and_or_b32 v52, v52, s11, v44
  v_and_or_b32 v53, v53, s11, v45
  v_and_or_b32 v54, v54, s11, v46
  v_and_or_b32 v55, v55, s11, v47
  buffer_store_dword v52, v7, s[48:51], s13 offen offset:2048 sc1
  buffer_store_dword v53, v7, s[48:51], s13 offen offset:2304 sc1
  buffer_store_dword v54, v7, s[48:51], s13 offen offset:2560 sc1
  buffer_store_dword v55, v7, s[48:51], s13 offen offset:2816 sc1
  s_waitcnt vmcnt(16)
  s_barrier
  ds_read_b128 v[20:23], v72 offset:0
  ds_read_b128 v[24:27], v73 offset:0
  ds_read_b128 v[28:31], v74 offset:0
  s_setprio 1
  ds_read_b128 v[32:35], v75 offset:0
  s_waitcnt lgkmcnt(3)
  v_mfma_f32_32x32x16_bf16 v[88:103], v[20:23], v[128:131], 0
  v_mfma_f32_32x32x16_bf16 v[104:119], v[20:23], v[192:195], 0
  ds_read_b128 v[20:23], v76 offset:0
  s_waitcnt lgkmcnt(3)
  v_mfma_f32_32x32x16_bf16 v[88:103], v[24:27], v[132:135], v[88:103]
  v_mfma_f32_32x32x16_bf16 v[104:119], v[24:27], v[196:199], v[104:119]
  ds_read_b128 v[24:27], v77 offset:0
  s_waitcnt lgkmcnt(3)
  v_mfma_f32_32x32x16_bf16 v[88:103], v[28:31], v[136:139], v[88:103]
  v_mfma_f32_32x32x16_bf16 v[104:119], v[28:31], v[200:203], v[104:119]
  ds_read_b128 v[28:31], v78 offset:0
  s_waitcnt lgkmcnt(3)
  v_mfma_f32_32x32x16_bf16 v[88:103], v[32:35], v[140:143], v[88:103]
  v_mfma_f32_32x32x16_bf16 v[104:119], v[32:35], v[204:207], v[104:119]
  ds_read_b128 v[32:35], v79 offset:0
  s_waitcnt lgkmcnt(3)
  v_mfma_f32_32x32x16_bf16 v[88:103], v[20:23], v[144:147], v[88:103]
  v_mfma_f32_32x32x16_bf16 v[104:119], v[20:23], v[208:211], v[104:119]
  ds_read_b128 v[20:23], v72 offset:256
  s_waitcnt lgkmcnt(3)
  v_mfma_f32_32x32x16_bf16 v[88:103], v[24:27], v[148:151], v[88:103]
  v_mfma_f32_32x32x16_bf16 v[104:119], v[24:27], v[212:215], v[104:119]
  ds_read_b128 v[24:27], v73 offset:256
  s_waitcnt lgkmcnt(3)
  v_mfma_f32_32x32x16_bf16 v[88:103], v[28:31], v[152:155], v[88:103]
  v_mfma_f32_32x32x16_bf16 v[104:119], v[28:31], v[216:219], v[104:119]
  ds_read_b128 v[28:31], v74 offset:256
  s_waitcnt lgkmcnt(3)
  v_mfma_f32_32x32x16_bf16 v[88:103], v[32:35], v[156:159], v[88:103]
  v_mfma_f32_32x32x16_bf16 v[104:119], v[32:35], v[220:223], v[104:119]
  ds_read_b128 v[32:35], v75 offset:256
  s_waitcnt lgkmcnt(3)
  v_mfma_f32_32x32x16_bf16 v[88:103], v[20:23], v[160:163], v[88:103]
  s_setprio 3
  v_mfma_f32_32x32x16_bf16 v[104:119], v[20:23], v[224:227], v[104:119]
  ds_read_b128 v[20:23], v76 offset:256
  s_waitcnt lgkmcnt(3)
  v_mfma_f32_32x32x16_bf16 v[88:103], v[24:27], v[164:167], v[88:103]
  v_mfma_f32_32x32x16_bf16 v[104:119], v[24:27], v[228:231], v[104:119]
  ds_read_b128 v[24:27], v77 offset:256
  s_waitcnt lgkmcnt(3)
  v_mfma_f32_32x32x16_bf16 v[88:103], v[28:31], v[168:171], v[88:103]
  v_mfma_f32_32x32x16_bf16 v[104:119], v[28:31], v[232:235], v[104:119]
  ds_read_b128 v[28:31], v78 offset:256
  s_waitcnt lgkmcnt(3)
  v_mfma_f32_32x32x16_bf16 v[88:103], v[32:35], v[172:175], v[88:103]
  v_mfma_f32_32x32x16_bf16 v[104:119], v[32:35], v[236:239], v[104:119]
  ds_read_b128 v[32:35], v79 offset:256
  s_waitcnt lgkmcnt(3)
  v_mfma_f32_32x32x16_bf16 v[88:103], v[20:23], v[176:179], v[88:103]
  v_mfma_f32_32x32x16_bf16 v[104:119], v[20:23], v[240:243], v[104:119]
  s_waitcnt lgkmcnt(2)
  v_mfma_f32_32x32x16_bf16 v[88:103], v[24:27], v[180:183], v[88:103]
  v_mfma_f32_32x32x16_bf16 v[104:119], v[24:27], v[244:247], v[104:119]
  s_waitcnt lgkmcnt(1)
  v_mfma_f32_32x32x16_bf16 v[88:103], v[28:31], v[184:187], v[88:103]
  v_mfma_f32_32x32x16_bf16 v[104:119], v[28:31], v[248:251], v[104:119]
  s_waitcnt lgkmcnt(0)
  v_mfma_f32_32x32x16_bf16 v[88:103], v[32:35], v[188:191], v[88:103]
  v_mfma_f32_32x32x16_bf16 v[104:119], v[32:35], v[252:255], v[104:119]
  s_setprio 0
  v_mov_b32 v58, 0
  global_load_dwordx2 v[58:59], v58, s[32:33] offset:128 sc1
  s_lshl_b32 s12, s65, 8
  s_add_u32 s13, s12, 4096
  s_nop 9
  v_rcp_f32 v48, v104
  v_rcp_f32 v49, v105
  v_rcp_f32 v50, v106
  v_rcp_f32 v51, v107
  v_mul_f32 v40, v38, v88
  v_mul_f32 v41, v38, v89
  v_mul_f32 v42, v38, v90
  v_mul_f32 v43, v38, v91
  v_med3_f32 v48, v48, -s10, s10
  v_med3_f32 v49, v49, -s10, s10
  v_med3_f32 v50, v50, -s10, s10
  v_med3_f32 v51, v51, -s10, s10
  v_cvt_pk_bf16_f32 v40, v40, 0
  v_add_u32 v48, 0x8000, v48
  v_cvt_pk_bf16_f32 v41, v41, 0
  v_add_u32 v49, 0x8000, v49
  v_cvt_pk_bf16_f32 v42, v42, 0
  v_add_u32 v50, 0x8000, v50
  v_cvt_pk_bf16_f32 v43, v43, 0
  v_add_u32 v51, 0x8000, v51
  v_sub_u32 v48, v48, v40
  v_sub_u32 v49, v49, v41
  v_sub_u32 v50, v50, v42
  v_sub_u32 v51, v51, v43
  v_and_or_b32 v48, v48, s11, v40
  v_and_or_b32 v49, v49, s11, v41
  v_and_or_b32 v50, v50, s11, v42
  v_and_or_b32 v51, v51, s11, v43
  buffer_store_dword v48, v7, s[48:51], s12 offen offset:0 sc1
  buffer_store_dword v49, v7, s[48:51], s12 offen offset:256 sc1
  buffer_store_dword v50, v7, s[48:51], s12 offen offset:512 sc1
  buffer_store_dword v51, v7, s[48:51], s12 offen offset:768 sc1
  v_rcp_f32 v52, v108
  v_rcp_f32 v53, v109
  v_rcp_f32 v54, v110
  v_rcp_f32 v55, v111
  v_mul_f32 v44, v38, v92
  v_mul_f32 v45, v38, v93
  v_mul_f32 v46, v38, v94
  v_mul_f32 v47, v38, v95
  v_med3_f32 v52, v52, -s10, s10
  v_med3_f32 v53, v53, -s10, s10
  v_med3_f32 v54, v54, -s10, s10
  v_med3_f32 v55, v55, -s10, s10
  v_cvt_pk_bf16_f32 v44, v44, 0
  v_add_u32 v52, 0x8000, v52
  v_cvt_pk_bf16_f32 v45, v45, 0
  v_add_u32 v53, 0x8000, v53
  v_cvt_pk_bf16_f32 v46, v46, 0
  v_add_u32 v54, 0x8000, v54
  v_cvt_pk_bf16_f32 v47, v47, 0
  v_add_u32 v55, 0x8000, v55
  v_sub_u32 v52, v52, v44
  v_sub_u32 v53, v53, v45
  v_sub_u32 v54, v54, v46
  v_sub_u32 v55, v55, v47
  v_and_or_b32 v52, v52, s11, v44
  v_and_or_b32 v53, v53, s11, v45
  v_and_or_b32 v54, v54, s11, v46
  v_and_or_b32 v55, v55, s11, v47
  buffer_store_dword v52, v7, s[48:51], s12 offen offset:2048 sc1
  buffer_store_dword v53, v7, s[48:51], s12 offen offset:2304 sc1
  buffer_store_dword v54, v7, s[48:51], s12 offen offset:2560 sc1
  buffer_store_dword v55, v7, s[48:51], s12 offen offset:2816 sc1
  v_rcp_f32 v48, v112
  v_rcp_f32 v49, v113
  v_rcp_f32 v50, v114
  v_rcp_f32 v51, v115
  v_mul_f32 v40, v38, v96
  v_mul_f32 v41, v38, v97
  v_mul_f32 v42, v38, v98
  v_mul_f32 v43, v38, v99
  v_med3_f32 v48, v48, -s10, s10
  v_med3_f32 v49, v49, -s10, s10
  v_med3_f32 v50, v50, -s10, s10
  v_med3_f32 v51, v51, -s10, s10
  v_cvt_pk_bf16_f32 v40, v40, 0
  v_add_u32 v48, 0x8000, v48
  v_cvt_pk_bf16_f32 v41, v41, 0
  v_add_u32 v49, 0x8000, v49
  v_cvt_pk_bf16_f32 v42, v42, 0
  v_add_u32 v50, 0x8000, v50
  v_cvt_pk_bf16_f32 v43, v43, 0
  v_add_u32 v51, 0x8000, v51
  v_sub_u32 v48, v48, v40
  v_sub_u32 v49, v49, v41
  v_sub_u32 v50, v50, v42
  v_sub_u32 v51, v51, v43
  v_and_or_b32 v48, v48, s11, v40
  v_and_or_b32 v49, v49, s11, v41
  v_and_or_b32 v50, v50, s11, v42
  v_and_or_b32 v51, v51, s11, v43
  buffer_store_dword v48, v7, s[48:51], s13 offen offset:0 sc1
  buffer_store_dword v49, v7, s[48:51], s13 offen offset:256 sc1
  buffer_store_dword v50, v7, s[48:51], s13 offen offset:512 sc1
  buffer_store_dword v51, v7, s[48:51], s13 offen offset:768 sc1
  v_rcp_f32 v52, v116
  v_rcp_f32 v53, v117
  v_rcp_f32 v54, v118
  v_rcp_f32 v55, v119
  v_mul_f32 v44, v38, v100
  v_mul_f32 v45, v38, v101
  v_mul_f32 v46, v38, v102
  v_mul_f32 v47, v38, v103
  v_med3_f32 v52, v52, -s10, s10
  v_med3_f32 v53, v53, -s10, s10
  v_med3_f32 v54, v54, -s10, s10
  v_med3_f32 v55, v55, -s10, s10
  v_cvt_pk_bf16_f32 v44, v44, 0
  v_add_u32 v52, 0x8000, v52
  v_cvt_pk_bf16_f32 v45, v45, 0
  v_add_u32 v53, 0x8000, v53
  v_cvt_pk_bf16_f32 v46, v46, 0
  v_add_u32 v54, 0x8000, v54
  v_cvt_pk_bf16_f32 v47, v47, 0
  v_add_u32 v55, 0x8000, v55
  v_sub_u32 v52, v52, v44
  v_sub_u32 v53, v53, v45
  v_sub_u32 v54, v54, v46
  v_sub_u32 v55, v55, v47
  v_and_or_b32 v52, v52, s11, v44
  v_and_or_b32 v53, v53, s11, v45
  v_and_or_b32 v54, v54, s11, v46
  v_and_or_b32 v55, v55, s11, v47
  buffer_store_dword v52, v7, s[48:51], s13 offen offset:2048 sc1
  buffer_store_dword v53, v7, s[48:51], s13 offen offset:2304 sc1
  buffer_store_dword v54, v7, s[48:51], s13 offen offset:2560 sc1
  buffer_store_dword v55, v7, s[48:51], s13 offen offset:2816 sc1
  s_bfe_u32 s66, s4, 0x10001
  s_mul_i32 s66, s66, 20
  s_add_u32 s66, s66, s59
  s_and_b32 s67, s4, 1
  s_add_u32 s3, s7, 4
  s_branch K1_FIN
K1_AUX:
  v_and_b32 v1, 15, v0
  v_lshlrev_b32 v1, 2, v1
  v_add_u32 v1, 151552, v1
  v_mov_b32 v36, 0
  ds_write_b32 v1, v36
  v_mov_b32 v58, 0
  v_mov_b32 v59, 0
  v_mov_b32 v57, 0
  s_mov_b32 s3, 9
  s_sub_u32 s61, s2, 80
  s_and_b32 s61, s61, 12
  s_add_u32 s61, s61, s4
  s_lshl_b32 s62, s61, 13
  s_lshl_b32 s63, s4, 12
  s_waitcnt lgkmcnt(0)
  s_mov_b32 s44, s24
  s_mov_b32 s45, s25
  s_mov_b32 s46, 131072
  s_mov_b32 s47, 0x20000
  s_mov_b32 s40, s28
  s_mov_b32 s41, s29
  s_mov_b32 s42, 131072
  s_mov_b32 s43, 0x20000
  s_mov_b32 s72, s18
  s_mov_b32 s73, s19
  s_mov_b32 s74, 5120000
  s_mov_b32 s75, 0x20000
  s_cmp_ge_u32 s4, 4
  s_cbranch_scc1 K1_AXT
  s_add_u32 m0, s63, 0
  s_add_u32 s8, s62, 0
  buffer_load_dwordx4 v8, s[40:43], s8 offen lds
  s_add_u32 m0, s63, 2048
  s_nop 0
  buffer_load_dwordx4 v8, s[44:47], s8 offen lds
  s_add_u32 m0, s63, 1024
  s_add_u32 s8, s62, 4096
  buffer_load_dwordx4 v8, s[40:43], s8 offen lds
  s_add_u32 m0, s63, 3072
  s_nop 0
  buffer_load_dwordx4 v8, s[44:47], s8 offen lds
  s_cmp_ge_u32 s2, 82
  s_cbranch_scc1 K1_NC1
  s_and_b32 s64, s2, 1
  s_lshl_b32 s64, s64, 2
  s_add_u32 s64, s64, s4
  s_lshl_b32 s8, s64, 6
  s_add_u32 s8, s8, 262144
  v_lshlrev_b32 v1, 12, v4
  v_lshl_add_u32 v1, v3, 1, v1
  v_add_u32 v1, s8, v1
  global_load_ushort v24, v1, s[28:29] offset:0
  global_load_ushort v25, v1, s[28:29] offset:512
  global_load_ushort v26, v1, s[28:29] offset:1024
  global_load_ushort v27, v1, s[28:29] offset:1536
  global_load_ushort v28, v1, s[28:29] offset:2048
  global_load_ushort v29, v1, s[28:29] offset:2560
  global_load_ushort v30, v1, s[28:29] offset:3072
  global_load_ushort v31, v1, s[28:29] offset:3584
K1_NC1:
  s_barrier
  v_bfe_u32 v6, v2, 2, 2
  v_lshl_add_u32 v7, v4, 3, v6
  v_lshlrev_b32 v7, 7, v7
  v_lshrrev_b32 v6, 1, v6
  v_lshl_add_u32 v7, v6, 6, v7
  v_bfe_u32 v6, v2, 4, 1
  v_lshl_add_u32 v7, v6, 5, v7
  v_and_b32 v6, 3, v2
  v_lshl_add_u32 v7, v6, 3, v7
  s_and_b32 s8, s4, 1
  s_lshl_b32 s9, s8, 6
  v_xor_b32 v6, s9, v7
  v_add_u32 v6, s63, v7
  v_xor_b32 v5, 64, v6
  s_lshl_b32 s61, s61, 10
  s_lshl_b32 s8, s7, 16
  s_add_u32 s8, s8, s61
  s_add_u32 s8, s8, 65536
  s_add_u32 s48, s34, s8
  s_addc_u32 s49, s35, 0
  s_mov_b32 s50, 65536
  s_mov_b32 s51, 0x20000
  v_lshlrev_b32 v1, 4, v2
  s_waitcnt vmcnt(0)
  ds_read_b64_tr_b16 v[128:129], v6 offset:0
  ds_read_b64_tr_b16 v[130:131], v6 offset:512
  ds_read_b64_tr_b16 v[132:133], v5 offset:0
  ds_read_b64_tr_b16 v[134:135], v5 offset:512
  ds_read_b64_tr_b16 v[136:137], v6 offset:2048
  ds_read_b64_tr_b16 v[138:139], v6 offset:2560
  ds_read_b64_tr_b16 v[140:141], v5 offset:2048
  ds_read_b64_tr_b16 v[142:143], v5 offset:2560
  s_cmp_ge_u32 s2, 82
  s_cbranch_scc1 K1_NC2
  v_lshlrev_b32 v24, 16, v24
  v_mul_f32 v24, 0xbfb8aa3b, v24
  v_lshlrev_b32 v25, 16, v25
  v_mul_f32 v25, 0xbfb8aa3b, v25
  v_lshlrev_b32 v26, 16, v26
  v_mul_f32 v26, 0xbfb8aa3b, v26
  v_lshlrev_b32 v27, 16, v27
  v_mul_f32 v27, 0xbfb8aa3b, v27
  v_lshlrev_b32 v28, 16, v28
  v_mul_f32 v28, 0xbfb8aa3b, v28
  v_lshlrev_b32 v29, 16, v29
  v_mul_f32 v29, 0xbfb8aa3b, v29
  v_lshlrev_b32 v30, 16, v30
  v_mul_f32 v30, 0xbfb8aa3b, v30
  v_lshlrev_b32 v31, 16, v31
  v_mul_f32 v31, 0xbfb8aa3b, v31
  v_cvt_pk_bf16_f32 v44, v24, v25
  v_cvt_pk_bf16_f32 v45, v26, v27
  v_cvt_pk_bf16_f32 v46, v28, v29
  v_cvt_pk_bf16_f32 v47, v30, v31
  s_lshl_b32 s64, s64, 10
  v_add_u32 v9, s64, v1
  global_store_dwordx4 v9, v[44:47], s[34:35] offset:0 sc1
K1_NC2:
  s_waitcnt lgkmcnt(0)
  s_mov_b32 s8, 0
  buffer_store_dwordx4 v[128:131], v1, s[48:51], s8 offen sc1
  s_mov_b32 s8, 16384
  buffer_store_dwordx4 v[132:135], v1, s[48:51], s8 offen sc1
  s_mov_b32 s8, 32768
  buffer_store_dwordx4 v[136:139], v1, s[48:51], s8 offen sc1
  s_mov_b32 s8, 49152
  buffer_store_dwordx4 v[140:143], v1, s[48:51], s8 offen sc1
  s_branch K1_FIN
K1_AXT:
  s_cmp_lg_u32 s2, 82
  s_cbranch_scc1 K1_NZ
  s_cmp_lg_u32 s4, 7
  s_cbranch_scc1 K1_NZ
  v_lshlrev_b32 v1, 8, v2
  v_add_u32 v1, 16384, v1
  global_store_dword v1, v58, s[34:35] sc0 sc1
  s_barrier
  v_mov_b32 v9, 1
  s_waitcnt vmcnt(0)
  s_mov_b64 exec, 1
  global_store_dword v58, v9, s[32:33] offset:128 sc0 sc1
  s_mov_b64 exec, -1
  s_branch K1_NZ2
K1_NZ:
  s_barrier
K1_NZ2:
  v_mov_b32 v1, 151600
  v_mov_b32 v3, 1
  v_mov_b32 v7, 0
  s_lshl_b32 s8, s3, 11
  s_add_u32 s8, s8, 16384
  v_and_b32 v4, 7, v0
  v_lshlrev_b32 v4, 8, v4
  v_add_u32 v4, s8, v4
  s_waitcnt vmcnt(0)
  s_mov_b64 exec, 1
  ds_add_rtn_u32 v5, v1, v3
  v_readfirstlane_b32 s49, v58
  v_readfirstlane_b32 s55, v59
  v_readfirstlane_b32 s48, v57
  s_cmp_eq_u32 s49, 0
  s_cselect_b32 s48, 0, s48
  s_waitcnt lgkmcnt(0)
  v_readfirstlane_b32 s8, v5
  s_cmp_lg_u32 s8, 7
  s_cbranch_scc1 KA_FIN2
  s_cmp_eq_u32 s3, 9
  s_cbranch_scc1 KA_FA
  s_mov_b32 s13, 0x40000
KA_ZP:
  s_cmp_lg_u32 s49, 0
  s_cbranch_scc1 KA_ZD
  global_load_dword v5, v7, s[32:33] offset:128 sc1
  s_waitcnt vmcnt(0)
  v_readfirstlane_b32 s49, v5
  s_sub_u32 s13, s13, 1
  s_cbranch_scc0 KA_ZP
KA_ZD:
  s_mov_b64 exec, 0xff
  global_atomic_add v4, v3, s[34:35]
  s_mov_b64 exec, 1
  ds_add_u32 v1, v3
  s_branch KA_FIN2
KA_FA:
  global_atomic_add v5, v7, v3, s[32:33] sc0
  ds_add_u32 v1, v3
  s_waitcnt vmcnt(0)
  v_readfirstlane_b32 s8, v5
  s_cmp_lg_u32 s8, 15
  s_cbranch_scc1 KA_FIN2
  global_store_dword v7, v3, s[32:33] offset:132 sc0 sc1
KA_FIN2:
  s_mov_b64 exec, -1
  v_lshlrev_b32 v20, 7, v2
  s_waitcnt vmcnt(0)
  s_branch K1_SKIPFIN
K1_PART:
  s_add_u32 s44, s18, s9
  s_addc_u32 s45, s19, 0
  s_mov_b32 s46, 128000
  s_mov_b32 s47, 0x20000
  s_barrier
  s_lshl_b32 s56, s4, 10
  s_lshl_b32 s14, s7, 16
  s_xor_b32 s57, s14, 0
  s_add_u32 s9, s56, s57
  s_mov_b32 m0, s9
  s_nop 0
  buffer_load_dwordx4 v6, s[44:47], s57 offen lds
  s_xor_b32 s57, s14, 8192
  s_add_u32 s9, s56, s57
  s_mov_b32 m0, s9
  s_nop 0
  buffer_load_dwordx4 v6, s[44:47], s57 offen lds
  s_xor_b32 s57, s14, 16384
  s_add_u32 s9, s56, s57
  s_mov_b32 m0, s9
  s_nop 0
  buffer_load_dwordx4 v6, s[44:47], s57 offen lds
  s_xor_b32 s57, s14, 24576
  s_add_u32 s9, s56, s57
  s_mov_b32 m0, s9
  s_nop 0
  buffer_load_dwordx4 v6, s[44:47], s57 offen lds
  s_add_u32 s48, s34, 524288
  s_addc_u32 s49, s35, 0
  s_mov_b32 s50, 2621440
  s_mov_b32 s51, 0x20000
  s_add_u32 s52, s34, 16777216
  s_addc_u32 s53, s35, 0
  s_mov_b32 s54, 20971520
  s_mov_b32 s55, 0x20000
  v_mov_b32 v43, 1
  v_mov_b32 v44, 152000
  s_movk_i32 s59, 488
  v_cmp_gt_u32 s[60:61], s59, v0
  s_mov_b32 s12, 429497
  s_lshl_b32 s13, s7, 8
  v_lshl_add_u32 v49, v2, 4, v44
  v_mov_b32 v54, 128000
  v_mov_b32 v55, 144000
  v_add_u32 v80, 0, v41
  v_add_u32 v81, 1, v41
  v_add_u32 v82, 2, v41
  v_add_u32 v83, 3, v41
  v_add_u32 v84, 2048, v41
  v_add_u32 v85, 2049, v41
  v_add_u32 v86, 2050, v41
  v_add_u32 v87, 2051, v41
  s_waitcnt vmcnt(6)
  v_lshrrev_b32 v72, 1, v8
  v_mul_u32_u24 v72, s12, v72
  v_lshrrev_b32 v24, 22, v72
  v_xor_b32 v24, s13, v24
  v_cmp_gt_u32 s[64:65], v40, v24
  v_lshl_add_u32 v64, v24, 2, v44
  v_lshrrev_b32 v73, 1, v9
  v_mul_u32_u24 v73, s12, v73
  v_lshrrev_b32 v25, 22, v73
  v_xor_b32 v25, s13, v25
  v_cmp_gt_u32 s[66:67], v40, v25
  v_lshl_add_u32 v65, v25, 2, v44
  v_lshrrev_b32 v74, 1, v10
  v_mul_u32_u24 v74, s12, v74
  v_lshrrev_b32 v26, 22, v74
  v_xor_b32 v26, s13, v26
  v_cmp_gt_u32 s[68:69], v40, v26
  v_lshl_add_u32 v66, v26, 2, v44
  v_lshrrev_b32 v75, 1, v11
  v_mul_u32_u24 v75, s12, v75
  v_lshrrev_b32 v27, 22, v75
  v_xor_b32 v27, s13, v27
  v_cmp_gt_u32 s[70:71], v40, v27
  v_lshl_add_u32 v67, v27, 2, v44
  v_lshrrev_b32 v76, 1, v12
  v_mul_u32_u24 v76, s12, v76
  v_lshrrev_b32 v28, 22, v76
  v_xor_b32 v28, s13, v28
  v_cmp_gt_u32 vcc, v40, v28
  v_lshl_add_u32 v68, v28, 2, v44
  s_and_b64 s[72:73], vcc, s[60:61]
  v_lshrrev_b32 v77, 1, v13
  v_mul_u32_u24 v77, s12, v77
  v_lshrrev_b32 v29, 22, v77
  v_xor_b32 v29, s13, v29
  v_cmp_gt_u32 vcc, v40, v29
  v_lshl_add_u32 v69, v29, 2, v44
  s_and_b64 s[74:75], vcc, s[60:61]
  v_lshrrev_b32 v78, 1, v14
  v_mul_u32_u24 v78, s12, v78
  v_lshrrev_b32 v30, 22, v78
  v_xor_b32 v30, s13, v30
  v_cmp_gt_u32 vcc, v40, v30
  v_lshl_add_u32 v70, v30, 2, v44
  s_and_b64 s[76:77], vcc, s[60:61]
  v_lshrrev_b32 v79, 1, v15
  v_mul_u32_u24 v79, s12, v79
  v_lshrrev_b32 v31, 22, v79
  v_xor_b32 v31, s13, v31
  v_cmp_gt_u32 vcc, v40, v31
  v_lshl_add_u32 v71, v31, 2, v44
  s_and_b64 s[78:79], vcc, s[60:61]
  s_mov_b64 exec, s[64:65]
  ds_add_rtn_u32 v32, v64, v43
  s_mov_b64 exec, s[66:67]
  ds_add_rtn_u32 v33, v65, v43
  s_mov_b64 exec, s[68:69]
  ds_add_rtn_u32 v34, v66, v43
  s_mov_b64 exec, s[70:71]
  ds_add_rtn_u32 v35, v67, v43
  s_mov_b64 exec, s[72:73]
  ds_add_rtn_u32 v36, v68, v43
  s_mov_b64 exec, s[74:75]
  ds_add_rtn_u32 v37, v69, v43
  s_mov_b64 exec, s[76:77]
  ds_add_rtn_u32 v38, v70, v43
  s_mov_b64 exec, s[78:79]
  ds_add_rtn_u32 v39, v71, v43
  s_mov_b64 exec, -1
  s_movk_i32 s12, 10000
  s_movk_i32 s13, 0x200
  s_xor_b32 s57, s14, 32768
  s_add_u32 s9, s56, s57
  s_mov_b32 m0, s9
  s_nop 0
  buffer_load_dwordx4 v6, s[44:47], s57 offen lds
  s_xor_b32 s57, s14, 40960
  s_add_u32 s9, s56, s57
  s_mov_b32 m0, s9
  s_nop 0
  buffer_load_dwordx4 v6, s[44:47], s57 offen lds
  s_xor_b32 s57, s14, 49152
  s_add_u32 s9, s56, s57
  s_mov_b32 m0, s9
  s_nop 0
  buffer_load_dwordx4 v6, s[44:47], s57 offen lds
  s_waitcnt vmcnt(7)
  v_and_b32 v45, 0x3fffff, v72
  v_mul_hi_u32_u24 v45, s12, v45
  v_bfe_u32 v46, s13, v45, 1
  v_mad_u32_u24 v45, v46, 3, v45
  v_and_b32 v46, 1, v8
  v_lshl_add_u32 v45, v45, 1, v46
  v_and_b32 v46, 7, v24
  v_lshl_add_u32 v16, v16, 3, v46
  v_lshl_add_u32 v16, v45, 17, v16
  v_and_b32 v45, 0x3fffff, v73
  v_mul_hi_u32_u24 v45, s12, v45
  v_bfe_u32 v46, s13, v45, 1
  v_mad_u32_u24 v45, v46, 3, v45
  v_and_b32 v46, 1, v9
  v_lshl_add_u32 v45, v45, 1, v46
  v_and_b32 v46, 7, v25
  v_lshl_add_u32 v17, v17, 3, v46
  v_lshl_add_u32 v17, v45, 17, v17
  s_waitcnt lgkmcnt(0)
  s_barrier
  ds_read_b128 v[88:91], v49
  s_xor_b32 s57, s14, 57344
  s_add_u32 s9, s56, s57
  s_cmp_ge_u32 s9, 128000
  s_cselect_b32 s9, 162816, s9
  s_mov_b32 m0, s9
  s_nop 0
  buffer_load_dwordx4 v6, s[44:47], s57 offen lds
  s_xor_b32 s57, s14, 65536
  s_add_u32 s9, s56, s57
  s_mov_b32 m0, s9
  s_nop 0
  buffer_load_dwordx4 v6, s[44:47], s57 offen lds
  s_xor_b32 s57, s14, 73728
  s_add_u32 s9, s56, s57
  s_mov_b32 m0, s9
  s_nop 0
  buffer_load_dwordx4 v6, s[44:47], s57 offen lds
  v_and_b32 v45, 0x3fffff, v74
  v_mul_hi_u32_u24 v45, s12, v45
  v_bfe_u32 v46, s13, v45, 1
  v_mad_u32_u24 v45, v46, 3, v45
  v_and_b32 v46, 1, v10
  v_lshl_add_u32 v45, v45, 1, v46
  v_and_b32 v46, 7, v26
  v_lshl_add_u32 v18, v18, 3, v46
  v_lshl_add_u32 v18, v45, 17, v18
  v_and_b32 v45, 0x3fffff, v75
  v_mul_hi_u32_u24 v45, s12, v45
  v_bfe_u32 v46, s13, v45, 1
  v_mad_u32_u24 v45, v46, 3, v45
  v_and_b32 v46, 1, v11
  v_lshl_add_u32 v45, v45, 1, v46
  v_and_b32 v46, 7, v27
  v_lshl_add_u32 v19, v19, 3, v46
  v_lshl_add_u32 v19, v45, 17, v19
  s_waitcnt lgkmcnt(0)
  v_add_u32 v93, v88, v89
  v_add_u32 v94, v93, v90
  v_add_u32 v51, v94, v91
  v_mov_b32 v50, v51
  v_and_b32 v46, 0x7f, v32
  v_lshlrev_b32 v96, 22, v46
  v_add_u32_dpp v51, v51, v51 row_shr:1 row_mask:0xf bank_mask:0xf
  v_and_b32 v46, 0x7f, v33
  v_lshlrev_b32 v97, 22, v46
  v_add_u32_dpp v51, v51, v51 row_shr:2 row_mask:0xf bank_mask:0xf
  v_and_b32 v46, 0x7f, v34
  v_lshlrev_b32 v98, 22, v46
  v_add_u32_dpp v51, v51, v51 row_shr:4 row_mask:0xf bank_mask:0xf
  v_and_b32 v46, 0x7f, v35
  v_lshlrev_b32 v99, 22, v46
  v_add_u32_dpp v51, v51, v51 row_shr:8 row_mask:0xf bank_mask:0xf
  v_and_b32 v46, 0x7f, v36
  v_lshlrev_b32 v100, 22, v46
  v_add_u32_dpp v51, v51, v51 row_bcast:15 row_mask:0xa bank_mask:0xf
  v_and_b32 v46, 0x7f, v37
  v_lshlrev_b32 v101, 22, v46
  v_add_u32_dpp v51, v51, v51 row_bcast:31 row_mask:0xc bank_mask:0xf
  v_and_b32 v46, 0x7f, v38
  v_lshlrev_b32 v102, 22, v46
  v_and_b32 v46, 0x7f, v39
  v_lshlrev_b32 v103, 22, v46
  v_sub_u32 v52, v51, v50
  v_add_u32 v95, v52, v94
  v_add_u32 v94, v52, v93
  v_add_u32 v93, v52, v88
  v_mov_b32 v92, v52
  ds_write_b128 v49, v[92:95] offset:1024
  ds_read_b32 v104, v64 offset:1024
  ds_read_b32 v105, v65 offset:1024
  ds_read_b32 v106, v66 offset:1024
  ds_read_b32 v107, v67 offset:1024
  ds_read_b32 v108, v68 offset:1024
  ds_read_b32 v109, v69 offset:1024
  ds_read_b32 v110, v70 offset:1024
  ds_read_b32 v111, v71 offset:1024
  s_xor_b32 s57, s14, 81920
  s_add_u32 s9, s56, s57
  s_mov_b32 m0, s9
  s_nop 0
  buffer_load_dwordx4 v6, s[44:47], s57 offen lds
  s_xor_b32 s57, s14, 90112
  s_add_u32 s9, s56, s57
  s_mov_b32 m0, s9
  s_nop 0
  buffer_load_dwordx4 v6, s[44:47], s57 offen lds
  v_and_b32 v45, 0x3fffff, v76
  v_mul_hi_u32_u24 v45, s12, v45
  v_bfe_u32 v46, s13, v45, 1
  v_mad_u32_u24 v45, v46, 3, v45
  v_and_b32 v46, 1, v12
  v_lshl_add_u32 v45, v45, 1, v46
  v_and_b32 v46, 7, v28
  v_lshl_add_u32 v20, v20, 3, v46
  v_lshl_add_u32 v20, v45, 17, v20
  v_and_b32 v45, 0x3fffff, v77
  v_mul_hi_u32_u24 v45, s12, v45
  v_bfe_u32 v46, s13, v45, 1
  v_mad_u32_u24 v45, v46, 3, v45
  v_and_b32 v46, 1, v13
  v_lshl_add_u32 v45, v45, 1, v46
  v_and_b32 v46, 7, v29
  v_lshl_add_u32 v21, v21, 3, v46
  v_lshl_add_u32 v21, v45, 17, v21
  s_xor_b32 s57, s14, 98304
  s_add_u32 s9, s56, s57
  s_mov_b32 m0, s9
  s_nop 0
  buffer_load_dwordx4 v6, s[44:47], s57 offen lds
  s_xor_b32 s57, s14, 106496
  s_add_u32 s9, s56, s57
  s_mov_b32 m0, s9
  s_nop 0
  buffer_load_dwordx4 v6, s[44:47], s57 offen lds
  v_and_b32 v45, 0x3fffff, v78
  v_mul_hi_u32_u24 v45, s12, v45
  v_bfe_u32 v46, s13, v45, 1
  v_mad_u32_u24 v45, v46, 3, v45
  v_and_b32 v46, 1, v14
  v_lshl_add_u32 v45, v45, 1, v46
  v_and_b32 v46, 7, v30
  v_lshl_add_u32 v22, v22, 3, v46
  v_lshl_add_u32 v22, v45, 17, v22
  v_and_b32 v45, 0x3fffff, v79
  v_mul_hi_u32_u24 v45, s12, v45
  v_bfe_u32 v46, s13, v45, 1
  v_mad_u32_u24 v45, v46, 3, v45
  v_and_b32 v46, 1, v15
  v_lshl_add_u32 v45, v45, 1, v46
  v_and_b32 v46, 7, v31
  v_lshl_add_u32 v23, v23, 3, v46
  v_lshl_add_u32 v23, v45, 17, v23
  v_mov_b32_dpp v47, v52 quad_perm:[0,0,2,2] row_mask:0xf bank_mask:0xf
  v_add_u32 v47, 120, v47
  v_sub_u32 v92, v47, v92
  v_med3_i32 v92, v92, 0, v88
  v_sub_u32 v93, v47, v93
  v_med3_i32 v93, v93, 0, v89
  v_sub_u32 v94, v47, v94
  v_med3_i32 v94, v94, 0, v90
  v_sub_u32 v95, v47, v95
  v_med3_i32 v95, v95, 0, v91
  v_lshl_or_b32 v92, v93, 16, v92
  v_lshl_or_b32 v93, v95, 16, v94
  v_lshlrev_b32 v92, 2, v92
  v_lshlrev_b32 v93, 2, v93
  v_lshlrev_b32 v45, 3, v2
  v_add_u32 v45, 154048, v45
  ds_write_b64 v45, v[92:93]
  s_lshl_b32 s12, s4, 3
  v_readlane_b32 s16, v52, s12
  s_add_u32 s12, s12, 1
  v_readlane_b32 s20, v51, s12
  s_add_u32 s12, s12, 1
  v_readlane_b32 s17, v52, s12
  s_add_u32 s12, s12, 1
  v_readlane_b32 s21, v51, s12
  s_add_u32 s12, s12, 1
  v_readlane_b32 s18, v52, s12
  s_add_u32 s12, s12, 1
  v_readlane_b32 s22, v51, s12
  s_add_u32 s12, s12, 1
  v_readlane_b32 s19, v52, s12
  s_add_u32 s12, s12, 1
  v_readlane_b32 s23, v51, s12
  s_add_u32 s12, s12, 1
  s_sub_u32 s20, s20, s16
  s_sub_u32 s21, s21, s17
  s_sub_u32 s22, s22, s18
  s_sub_u32 s23, s23, s19
  s_waitcnt lgkmcnt(1)
  v_add_u32 v8, v104, v32
  v_or_b32 v16, v16, v96
  v_lshl_add_u32 v64, v8, 2, v54
  v_lshl_add_u32 v8, v8, 1, v55
  v_add_u32 v9, v105, v33
  v_or_b32 v17, v17, v97
  v_lshl_add_u32 v65, v9, 2, v54
  v_lshl_add_u32 v9, v9, 1, v55
  v_add_u32 v10, v106, v34
  v_or_b32 v18, v18, v98
  v_lshl_add_u32 v66, v10, 2, v54
  v_lshl_add_u32 v10, v10, 1, v55
  v_add_u32 v11, v107, v35
  v_or_b32 v19, v19, v99
  v_lshl_add_u32 v67, v11, 2, v54
  v_lshl_add_u32 v11, v11, 1, v55
  v_add_u32 v12, v108, v36
  v_or_b32 v20, v20, v100
  v_lshl_add_u32 v68, v12, 2, v54
  v_lshl_add_u32 v12, v12, 1, v55
  v_add_u32 v13, v109, v37
  v_or_b32 v21, v21, v101
  v_lshl_add_u32 v69, v13, 2, v54
  v_lshl_add_u32 v13, v13, 1, v55
  v_add_u32 v14, v110, v38
  v_or_b32 v22, v22, v102
  v_lshl_add_u32 v70, v14, 2, v54
  v_lshl_add_u32 v14, v14, 1, v55
  v_add_u32 v15, v111, v39
  v_or_b32 v23, v23, v103
  v_lshl_add_u32 v71, v15, 2, v54
  v_lshl_add_u32 v15, v15, 1, v55
  s_mov_b64 exec, s[64:65]
  ds_write_b32 v64, v16
  ds_write_b16 v8, v80
  s_mov_b64 exec, s[66:67]
  ds_write_b32 v65, v17
  ds_write_b16 v9, v81
  s_mov_b64 exec, s[68:69]
  ds_write_b32 v66, v18
  ds_write_b16 v10, v82
  s_mov_b64 exec, s[70:71]
  ds_write_b32 v67, v19
  ds_write_b16 v11, v83
  s_mov_b64 exec, s[72:73]
  ds_write_b32 v68, v20
  ds_write_b16 v12, v84
  s_mov_b64 exec, s[74:75]
  ds_write_b32 v69, v21
  ds_write_b16 v13, v85
  s_mov_b64 exec, s[76:77]
  ds_write_b32 v70, v22
  ds_write_b16 v14, v86
  s_mov_b64 exec, s[78:79]
  ds_write_b32 v71, v23
  ds_write_b16 v15, v87
  s_mov_b64 exec, -1
  s_xor_b32 s57, s14, 114688
  s_add_u32 s9, s56, s57
  s_mov_b32 m0, s9
  s_nop 0
  buffer_load_dwordx4 v6, s[44:47], s57 offen lds
  s_xor_b32 s57, s14, 122880
  s_add_u32 s9, s56, s57
  s_cmp_ge_u32 s9, 128000
  s_cselect_b32 s9, 162816, s9
  s_mov_b32 m0, s9
  s_nop 0
  buffer_load_dwordx4 v6, s[44:47], s57 offen lds
  v_lshlrev_b32 v56, 1, v2
  v_or_b32 v57, 1, v56
  v_lshl_add_u32 v54, v2, 3, v54
  v_lshrrev_b32 v58, 1, v2
  v_lshl_add_u32 v55, v58, 1, v55
  v_and_b32 v59, 1, v2
  s_lshl_b32 s8, s4, 6
  s_add_u32 s8, s8, 154048
  v_lshl_add_u32 v47, v59, 3, s8
  v_lshlrev_b32 v59, 4, v59
  v_lshlrev_b32 v61, 3, v2
  v_lshlrev_b32 v62, 4, v2
  v_add_u32 v63, 32, v58
  v_add_u32 v48, 64, v58
  s_lshl_b32 s58, s7, 3
  s_add_u32 s58, s58, s4
  s_mul_i32 s58, s58, 160
  s_add_u32 s58, s58, s5
  s_mov_b32 s60, 0
  s_mov_b32 s61, 0x30000000
  s_waitcnt lgkmcnt(0)
  s_barrier
  v_lshl_add_u32 v46, s16, 1, v55
  ds_read_u16 v64, v46 offset:0
  ds_read_u16 v65, v46 offset:64
  ds_read_u16 v66, v46 offset:128
  v_lshl_add_u32 v46, s17, 1, v55
  ds_read_u16 v67, v46 offset:0
  ds_read_u16 v68, v46 offset:64
  ds_read_u16 v69, v46 offset:128
  v_lshl_add_u32 v46, s18, 1, v55
  ds_read_u16 v70, v46 offset:0
  ds_read_u16 v71, v46 offset:64
  ds_read_u16 v72, v46 offset:128
  v_lshl_add_u32 v46, s19, 1, v55
  ds_read_u16 v73, v46 offset:0
  ds_read_u16 v74, v46 offset:64
  ds_read_u16 v75, v46 offset:128
  v_lshl_add_u32 v46, s16, 2, v54
  ds_read2_b32 v[8:9], v46 offset0:0 offset1:1
  ds_read_b64 v[24:25], v47 offset:0
  v_lshl_add_u32 v46, s17, 2, v54
  ds_read2_b32 v[10:11], v46 offset0:0 offset1:1
  ds_read_b64 v[26:27], v47 offset:16
  v_lshl_add_u32 v46, s18, 2, v54
  ds_read2_b32 v[12:13], v46 offset0:0 offset1:1
  ds_read_b64 v[28:29], v47 offset:32
  v_lshl_add_u32 v46, s19, 2, v54
  ds_read2_b32 v[14:15], v46 offset0:0 offset1:1
  ds_read_b64 v[30:31], v47 offset:48
  s_waitcnt lgkmcnt(8)
  v_lshl_add_u32 v64, v64, 5, v59
  v_lshl_add_u32 v65, v65, 5, v59
  v_lshl_add_u32 v66, v66, 5, v59
  v_lshl_add_u32 v67, v67, 5, v59
  v_lshl_add_u32 v68, v68, 5, v59
  v_lshl_add_u32 v69, v69, 5, v59
  v_lshl_add_u32 v70, v70, 5, v59
  v_lshl_add_u32 v71, v71, 5, v59
  v_lshl_add_u32 v72, v72, 5, v59
  v_lshl_add_u32 v73, v73, 5, v59
  v_lshl_add_u32 v74, v74, 5, v59
  v_lshl_add_u32 v75, v75, 5, v59
  v_mov_b32 v200, 0
  global_load_dwordx2 v[204:205], v200, s[32:33] offset:128 sc1
  s_waitcnt lgkmcnt(0)
  s_min_u32 s9, s20, 120
  v_cmp_gt_u32 s[28:29], s9, v56
  v_cmp_gt_u32 s[62:63], s9, v57
  s_add_u32 s8, s58, 0
  s_lshl_b32 s8, s8, 9
  v_cndmask_b32 v8, -1, v8, s[28:29]
  v_cndmask_b32 v9, -1, v9, s[62:63]
  v_cndmask_b32 v8, v8, v24, s[60:61]
  v_cndmask_b32 v9, v9, v25, s[60:61]
  s_cmp_gt_u32 s20, 96
  s_cbranch_scc1 K1_BG0
K1_BGR0:
  buffer_store_dwordx2 v[8:9], v61, s[48:51], s8 offen sc1
  s_add_u32 s24, s20, 3
  s_andn2_b32 s24, s24, 3
  s_min_u32 s9, s21, 120
  v_cmp_gt_u32 s[28:29], s9, v56
  v_cmp_gt_u32 s[62:63], s9, v57
  s_add_u32 s8, s58, 40
  s_lshl_b32 s8, s8, 9
  v_cndmask_b32 v10, -1, v10, s[28:29]
  v_cndmask_b32 v11, -1, v11, s[62:63]
  v_cndmask_b32 v10, v10, v26, s[60:61]
  v_cndmask_b32 v11, v11, v27, s[60:61]
  s_cmp_gt_u32 s21, 96
  s_cbranch_scc1 K1_BG1
K1_BGR1:
  buffer_store_dwordx2 v[10:11], v61, s[48:51], s8 offen sc1
  s_add_u32 s25, s21, 3
  s_andn2_b32 s25, s25, 3
  s_min_u32 s9, s22, 120
  v_cmp_gt_u32 s[28:29], s9, v56
  v_cmp_gt_u32 s[62:63], s9, v57
  s_add_u32 s8, s58, 80
  s_lshl_b32 s8, s8, 9
  v_cndmask_b32 v12, -1, v12, s[28:29]
  v_cndmask_b32 v13, -1, v13, s[62:63]
  v_cndmask_b32 v12, v12, v28, s[60:61]
  v_cndmask_b32 v13, v13, v29, s[60:61]
  s_cmp_gt_u32 s22, 96
  s_cbranch_scc1 K1_BG2
K1_BGR2:
  buffer_store_dwordx2 v[12:13], v61, s[48:51], s8 offen sc1
  s_add_u32 s26, s22, 3
  s_andn2_b32 s26, s26, 3
  s_min_u32 s9, s23, 120
  v_cmp_gt_u32 s[28:29], s9, v56
  v_cmp_gt_u32 s[62:63], s9, v57
  s_add_u32 s8, s58, 120
  s_lshl_b32 s8, s8, 9
  v_cndmask_b32 v14, -1, v14, s[28:29]
  v_cndmask_b32 v15, -1, v15, s[62:63]
  v_cndmask_b32 v14, v14, v30, s[60:61]
  v_cndmask_b32 v15, v15, v31, s[60:61]
  s_cmp_gt_u32 s23, 96
  s_cbranch_scc1 K1_BG3
K1_BGR3:
  buffer_store_dwordx2 v[14:15], v61, s[48:51], s8 offen sc1
  s_add_u32 s27, s23, 3
  s_andn2_b32 s27, s27, 3
  s_waitcnt vmcnt(4)
  s_barrier
  s_cmp_gt_u32 s20, 96
  s_cbranch_scc1 K1_OV0
K1_OVR0:
  s_cmp_gt_u32 s21, 96
  s_cbranch_scc1 K1_OV1
K1_OVR1:
  s_cmp_gt_u32 s22, 96
  s_cbranch_scc1 K1_OV2
K1_OVR2:
  s_cmp_gt_u32 s23, 96
  s_cbranch_scc1 K1_OV3
K1_OVR3:
  ds_read_b128 v[96:99], v64 offset:0
  ds_read_b128 v[100:103], v65 offset:0
  ds_read_b128 v[104:107], v66 offset:0
  ds_read_b128 v[108:111], v67 offset:0
  ds_read_b128 v[112:115], v68 offset:0
  ds_read_b128 v[116:119], v69 offset:0
  ds_read_b128 v[120:123], v70 offset:0
  ds_read_b128 v[124:127], v71 offset:0
  ds_read_b128 v[128:131], v72 offset:0
  ds_read_b128 v[132:135], v73 offset:0
  ds_read_b128 v[136:139], v74 offset:0
  ds_read_b128 v[140:143], v75 offset:0
  s_add_u32 s8, s58, 0
  s_mul_i32 s8, s8, 3840
  s_waitcnt lgkmcnt(9)
  v_cmpx_gt_u32 vcc, s24, v58
  buffer_store_dwordx4 v[96:99], v62, s[52:55], s8 offen offset:0 sc1
  v_cmpx_gt_u32 vcc, s24, v63
  buffer_store_dwordx4 v[100:103], v62, s[52:55], s8 offen offset:1024 sc1
  v_cmpx_gt_u32 vcc, s24, v48
  s_cbranch_execz K1_SK0
  buffer_store_dwordx4 v[104:107], v62, s[52:55], s8 offen offset:2048 sc1
K1_SK0:
  s_mov_b64 exec, -1
  s_waitcnt lgkmcnt(0)
  s_barrier
  v_and_b32 v1, 15, v0
  v_lshlrev_b32 v1, 2, v1
  v_add_u32 v1, 151552, v1
  v_mov_b32 v36, 0
  ds_write_b32 v1, v36
  s_waitcnt lgkmcnt(0)
  s_barrier
  s_add_u32 s8, s58, 40
  s_mul_i32 s8, s8, 3840
  s_waitcnt lgkmcnt(6)
  v_cmpx_gt_u32 vcc, s25, v58
  buffer_store_dwordx4 v[108:111], v62, s[52:55], s8 offen offset:0 sc1
  v_cmpx_gt_u32 vcc, s25, v63
  buffer_store_dwordx4 v[112:115], v62, s[52:55], s8 offen offset:1024 sc1
  v_cmpx_gt_u32 vcc, s25, v48
  s_cbranch_execz K1_SK1
  buffer_store_dwordx4 v[116:119], v62, s[52:55], s8 offen offset:2048 sc1
K1_SK1:
  s_mov_b64 exec, -1
  s_add_u32 s8, s58, 80
  s_mul_i32 s8, s8, 3840
  s_waitcnt lgkmcnt(3)
  v_cmpx_gt_u32 vcc, s26, v58
  buffer_store_dwordx4 v[120:123], v62, s[52:55], s8 offen offset:0 sc1
  v_cmpx_gt_u32 vcc, s26, v63
  buffer_store_dwordx4 v[124:127], v62, s[52:55], s8 offen offset:1024 sc1
  v_cmpx_gt_u32 vcc, s26, v48
  s_cbranch_execz K1_SK2
  buffer_store_dwordx4 v[128:131], v62, s[52:55], s8 offen offset:2048 sc1
K1_SK2:
  s_mov_b64 exec, -1
  s_add_u32 s8, s58, 120
  s_mul_i32 s8, s8, 3840
  s_waitcnt lgkmcnt(0)
  v_cmpx_gt_u32 vcc, s27, v58
  buffer_store_dwordx4 v[132:135], v62, s[52:55], s8 offen offset:0 sc1
  v_cmpx_gt_u32 vcc, s27, v63
  buffer_store_dwordx4 v[136:139], v62, s[52:55], s8 offen offset:1024 sc1
  v_cmpx_gt_u32 vcc, s27, v48
  s_cbranch_execz K1_SK3
  buffer_store_dwordx4 v[140:143], v62, s[52:55], s8 offen offset:2048 sc1
K1_SK3:
  s_mov_b64 exec, -1
  s_lshl_b32 s66, s6, 2
  s_lshr_b32 s67, s4, 1
  s_add_u32 s66, s66, s67
  s_and_b32 s67, s4, 1
  s_add_u32 s3, s7, 2
  v_mov_b32 v58, v204
  v_mov_b32 v59, v205
  s_branch K1_FIN
K1_END:
  s_endpgm
K1_BG0:
  v_readlane_b32 s9, v8, 60
  s_or_b32 s9, s9, 0x8000
  s_cmp_gt_u32 s20, 120
  s_cselect_b32 s12, 0x4000, 0
  s_or_b32 s9, s9, s12
  v_writelane_b32 v8, s9, 60
  s_cmp_gt_u32 s20, 120
  s_cbranch_scc0 K1_BGR0
  s_sub_u32 s9, s20, 120
  s_lshl_b32 s9, s9, 13
  s_add_u32 s9, s9, s16
  s_add_u32 s9, s9, 120
  s_or_b32 s9, s9, 0x80000000
  v_writelane_b32 v9, s9, 63
  s_branch K1_BGR0
K1_OV0:
  s_movk_i32 s59, 96
K1_OL0:
  v_add_u32 v45, s59, v58
  v_add_u32 v46, s16, v45
  v_lshlrev_b32 v47, 1, v46
  v_add_u32 v47, 144000, v47
  ds_read_u16 v50, v47
  v_lshlrev_b32 v47, 2, v46
  v_add_u32 v47, 128000, v47
  ds_read_b32 v51, v47
  s_waitcnt lgkmcnt(0)
  v_lshl_add_u32 v50, v50, 5, v59
  ds_read_b128 v[200:203], v50 offset:0
  s_add_u32 s9, s58, 0
  s_lshl_b32 s9, s9, 7
  v_add_u32 v52, s9, v45
  s_lshl_b32 s9, s5, 1
  s_add_u32 s9, s9, s7
  s_lshl_b32 s9, s9, 12
  s_add_u32 s9, s9, 327680
  v_add_u32 v46, s9, v46
  s_add_u32 s9, s58, 0
  s_mul_i32 s9, s9, 256
  v_mov_b32 v53, s9
  v_cmp_gt_u32 vcc, 120, v45
  s_nop 1
  v_cndmask_b32 v52, v46, v52, vcc
  v_cndmask_b32_e64 v53, 0, v53, vcc
  v_cmpx_gt_u32 vcc, s20, v45
  v_lshlrev_b32 v47, 2, v52
  v_lshl_add_u32 v52, v52, 5, v59
  v_sub_u32 v52, v52, v53
  s_waitcnt lgkmcnt(0)
  buffer_store_dword v51, v47, s[48:51], 0 offen sc1
  buffer_store_dwordx4 v[200:203], v52, s[52:55], 0 offen sc1
  s_mov_b64 exec, -1
  s_add_u32 s59, s59, 32
  s_cmp_lt_u32 s59, s20
  s_cbranch_scc1 K1_OL0
  s_waitcnt lgkmcnt(0)
  s_branch K1_OVR0
K1_BG1:
  v_readlane_b32 s9, v10, 60
  s_or_b32 s9, s9, 0x8000
  s_cmp_gt_u32 s21, 120
  s_cselect_b32 s12, 0x4000, 0
  s_or_b32 s9, s9, s12
  v_writelane_b32 v10, s9, 60
  s_cmp_gt_u32 s21, 120
  s_cbranch_scc0 K1_BGR1
  s_sub_u32 s9, s21, 120
  s_lshl_b32 s9, s9, 13
  s_add_u32 s9, s9, s17
  s_add_u32 s9, s9, 120
  s_or_b32 s9, s9, 0x80000000
  v_writelane_b32 v11, s9, 63
  s_branch K1_BGR1
K1_OV1:
  s_movk_i32 s59, 96
K1_OL1:
  v_add_u32 v45, s59, v58
  v_add_u32 v46, s17, v45
  v_lshlrev_b32 v47, 1, v46
  v_add_u32 v47, 144000, v47
  ds_read_u16 v50, v47
  v_lshlrev_b32 v47, 2, v46
  v_add_u32 v47, 128000, v47
  ds_read_b32 v51, v47
  s_waitcnt lgkmcnt(0)
  v_lshl_add_u32 v50, v50, 5, v59
  ds_read_b128 v[200:203], v50 offset:0
  s_add_u32 s9, s58, 40
  s_lshl_b32 s9, s9, 7
  v_add_u32 v52, s9, v45
  s_lshl_b32 s9, s5, 1
  s_add_u32 s9, s9, s7
  s_lshl_b32 s9, s9, 12
  s_add_u32 s9, s9, 327680
  v_add_u32 v46, s9, v46
  s_add_u32 s9, s58, 40
  s_mul_i32 s9, s9, 256
  v_mov_b32 v53, s9
  v_cmp_gt_u32 vcc, 120, v45
  s_nop 1
  v_cndmask_b32 v52, v46, v52, vcc
  v_cndmask_b32_e64 v53, 0, v53, vcc
  v_cmpx_gt_u32 vcc, s21, v45
  v_lshlrev_b32 v47, 2, v52
  v_lshl_add_u32 v52, v52, 5, v59
  v_sub_u32 v52, v52, v53
  s_waitcnt lgkmcnt(0)
  buffer_store_dword v51, v47, s[48:51], 0 offen sc1
  buffer_store_dwordx4 v[200:203], v52, s[52:55], 0 offen sc1
  s_mov_b64 exec, -1
  s_add_u32 s59, s59, 32
  s_cmp_lt_u32 s59, s21
  s_cbranch_scc1 K1_OL1
  s_waitcnt lgkmcnt(0)
  s_branch K1_OVR1
K1_BG2:
  v_readlane_b32 s9, v12, 60
  s_or_b32 s9, s9, 0x8000
  s_cmp_gt_u32 s22, 120
  s_cselect_b32 s12, 0x4000, 0
  s_or_b32 s9, s9, s12
  v_writelane_b32 v12, s9, 60
  s_cmp_gt_u32 s22, 120
  s_cbranch_scc0 K1_BGR2
  s_sub_u32 s9, s22, 120
  s_lshl_b32 s9, s9, 13
  s_add_u32 s9, s9, s18
  s_add_u32 s9, s9, 120
  s_or_b32 s9, s9, 0x80000000
  v_writelane_b32 v13, s9, 63
  s_branch K1_BGR2
K1_OV2:
  s_movk_i32 s59, 96
K1_OL2:
  v_add_u32 v45, s59, v58
  v_add_u32 v46, s18, v45
  v_lshlrev_b32 v47, 1, v46
  v_add_u32 v47, 144000, v47
  ds_read_u16 v50, v47
  v_lshlrev_b32 v47, 2, v46
  v_add_u32 v47, 128000, v47
  ds_read_b32 v51, v47
  s_waitcnt lgkmcnt(0)
  v_lshl_add_u32 v50, v50, 5, v59
  ds_read_b128 v[200:203], v50 offset:0
  s_add_u32 s9, s58, 80
  s_lshl_b32 s9, s9, 7
  v_add_u32 v52, s9, v45
  s_lshl_b32 s9, s5, 1
  s_add_u32 s9, s9, s7
  s_lshl_b32 s9, s9, 12
  s_add_u32 s9, s9, 327680
  v_add_u32 v46, s9, v46
  s_add_u32 s9, s58, 80
  s_mul_i32 s9, s9, 256
  v_mov_b32 v53, s9
  v_cmp_gt_u32 vcc, 120, v45
  s_nop 1
  v_cndmask_b32 v52, v46, v52, vcc
  v_cndmask_b32_e64 v53, 0, v53, vcc
  v_cmpx_gt_u32 vcc, s22, v45
  v_lshlrev_b32 v47, 2, v52
  v_lshl_add_u32 v52, v52, 5, v59
  v_sub_u32 v52, v52, v53
  s_waitcnt lgkmcnt(0)
  buffer_store_dword v51, v47, s[48:51], 0 offen sc1
  buffer_store_dwordx4 v[200:203], v52, s[52:55], 0 offen sc1
  s_mov_b64 exec, -1
  s_add_u32 s59, s59, 32
  s_cmp_lt_u32 s59, s22
  s_cbranch_scc1 K1_OL2
  s_waitcnt lgkmcnt(0)
  s_branch K1_OVR2
K1_BG3:
  v_readlane_b32 s9, v14, 60
  s_or_b32 s9, s9, 0x8000
  s_cmp_gt_u32 s23, 120
  s_cselect_b32 s12, 0x4000, 0
  s_or_b32 s9, s9, s12
  v_writelane_b32 v14, s9, 60
  s_cmp_gt_u32 s23, 120
  s_cbranch_scc0 K1_BGR3
  s_sub_u32 s9, s23, 120
  s_lshl_b32 s9, s9, 13
  s_add_u32 s9, s9, s19
  s_add_u32 s9, s9, 120
  s_or_b32 s9, s9, 0x80000000
  v_writelane_b32 v15, s9, 63
  s_branch K1_BGR3
K1_OV3:
  s_movk_i32 s59, 96
K1_OL3:
  v_add_u32 v45, s59, v58
  v_add_u32 v46, s19, v45
  v_lshlrev_b32 v47, 1, v46
  v_add_u32 v47, 144000, v47
  ds_read_u16 v50, v47
  v_lshlrev_b32 v47, 2, v46
  v_add_u32 v47, 128000, v47
  ds_read_b32 v51, v47
  s_waitcnt lgkmcnt(0)
  v_lshl_add_u32 v50, v50, 5, v59
  ds_read_b128 v[200:203], v50 offset:0
  s_add_u32 s9, s58, 120
  s_lshl_b32 s9, s9, 7
  v_add_u32 v52, s9, v45
  s_lshl_b32 s9, s5, 1
  s_add_u32 s9, s9, s7
  s_lshl_b32 s9, s9, 12
  s_add_u32 s9, s9, 327680
  v_add_u32 v46, s9, v46
  s_add_u32 s9, s58, 120
  s_mul_i32 s9, s9, 256
  v_mov_b32 v53, s9
  v_cmp_gt_u32 vcc, 120, v45
  s_nop 1
  v_cndmask_b32 v52, v46, v52, vcc
  v_cndmask_b32_e64 v53, 0, v53, vcc
  v_cmpx_gt_u32 vcc, s23, v45
  v_lshlrev_b32 v47, 2, v52
  v_lshl_add_u32 v52, v52, 5, v59
  v_sub_u32 v52, v52, v53
  s_waitcnt lgkmcnt(0)
  buffer_store_dword v51, v47, s[48:51], 0 offen sc1
  buffer_store_dwordx4 v[200:203], v52, s[52:55], 0 offen sc1
  s_mov_b64 exec, -1
  s_add_u32 s59, s59, 32
  s_cmp_lt_u32 s59, s23
  s_cbranch_scc1 K1_OL3
  s_waitcnt lgkmcnt(0)
  s_branch K1_OVR3
K1_FIN:
  s_cmp_lt_u32 s4, 4
  s_cbranch_scc1 K1_SKIPFIN
  s_setprio 3
  v_mov_b32 v1, 151600
  v_mov_b32 v3, 1
  v_mov_b32 v7, 0
  s_lshl_b32 s8, s3, 11
  s_add_u32 s8, s8, 16384
  v_and_b32 v4, 7, v0
  v_lshlrev_b32 v4, 8, v4
  v_add_u32 v4, s8, v4
  s_waitcnt vmcnt(0)
  s_mov_b64 exec, 1
  ds_add_rtn_u32 v5, v1, v3
  v_readfirstlane_b32 s49, v58
  v_readfirstlane_b32 s55, v59
  v_readfirstlane_b32 s48, v57
  s_cmp_eq_u32 s49, 0
  s_cselect_b32 s48, 0, s48
  s_waitcnt lgkmcnt(0)
  v_readfirstlane_b32 s8, v5
  s_cmp_lg_u32 s8, 7
  s_cbranch_scc1 K1_FIN2
  s_cmp_eq_u32 s3, 9
  s_cbranch_scc1 K1_FA
  s_mov_b32 s13, 0x40000
K1_ZP:
  s_cmp_lg_u32 s49, 0
  s_cbranch_scc1 K1_ZD
  global_load_dword v5, v7, s[32:33] offset:128 sc1
  s_waitcnt vmcnt(0)
  v_readfirstlane_b32 s49, v5
  s_sub_u32 s13, s13, 1
  s_cbranch_scc0 K1_ZP
K1_ZD:
  s_mov_b64 exec, 0xff
  global_atomic_add v4, v3, s[34:35]
  s_mov_b64 exec, 1
  ds_add_u32 v1, v3
  s_branch K1_FIN2
K1_FA:
  global_atomic_add v5, v7, v3, s[32:33] sc0
  ds_add_u32 v1, v3
  s_waitcnt vmcnt(0)
  v_readfirstlane_b32 s8, v5
  s_cmp_lg_u32 s8, 15
  s_cbranch_scc1 K1_FIN2
  global_store_dword v7, v3, s[32:33] offset:132 sc0 sc1
K1_FIN2:
  s_setprio 0
  s_mov_b64 exec, -1
K1_SKIPFIN:
  s_mov_b64 s[50:51], s[32:33]
  s_load_dwordx2 s[34:35], s[0:1], 72
  s_load_dwordx2 s[32:33], s[0:1], 56
  s_load_dwordx2 s[38:39], s[0:1], 0
  v_lshrrev_b32 v11, 6, v0
  v_and_b32 v1, 63, v0
  v_readfirstlane_b32 s4, v11
  v_and_b32 v2, 31, v1
  v_lshrrev_b32 v3, 5, v1
  s_xor_b32 s4, s4, 4
  s_and_b32 s7, s2, 3
  s_and_b32 s8, s2, 4
  s_lshl_b32 s8, s8, 6
  s_and_b32 s77, s2, 0xf8
  s_add_u32 s77, s77, s8
  s_mul_i32 s10, s4, 8192
  v_lshlrev_b32 v11, 2, v1
  s_mul_i32 s63, s77, 5
  s_mul_i32 s64, s77, 625
  s_add_u32 s64, s64, 63
  s_lshr_b32 s64, s64, 6
  s_lshl_b32 s8, s4, 2
  s_add_u32 s8, s8, 151552
  v_mov_b32 v251, s8
  v_mov_b32 v10, 0
  v_mov_b32 v250, 151552
  s_cmp_ge_u32 s4, 4
  s_cbranch_scc1 K2_HI
  v_lshlrev_b32 v14, 9, v1
  v_cmp_gt_u32 vcc, 40, v1
  v_mov_b32 v13, 0x7ffffff0
  s_add_u32 s62, s63, s4
  s_lshl_b32 s62, s62, 9
  v_cndmask_b32 v14, v13, v14, vcc
  s_lshl_b32 s8, s63, 9
  s_waitcnt lgkmcnt(0)
  s_add_u32 s20, s34, 524288
  s_addc_u32 s21, s35, 0
  s_mov_b32 s22, 2621440
  s_mov_b32 s23, 0x20000
  v_mov_b32 v158, v14
  v_lshlrev_b32 v157, 11, v3
  v_lshl_add_u32 v157, v2, 2, v157
K2_AR:
  ds_read_b32 v252, v250 offset:48
  s_waitcnt lgkmcnt(0)
  v_readfirstlane_b32 s9, v252
  s_cmp_lt_u32 s9, 8
  s_cbranch_scc1 K2_AR
  s_mul_i32 s8, s7, 2560000
  s_add_u32 s8, s8, 4194304
  s_add_u32 s12, s34, s8
  s_addc_u32 s13, s35, 0
  s_and_b32 s13, s13, 0xffff
  s_or_b32 s13, s13, 0x80000000
  s_mov_b32 s14, -1
  s_mov_b32 s15, 0xc00000
  s_add_u32 s24, s34, 16777216
  s_addc_u32 s25, s35, 0
  s_mov_b32 s26, 20971520
  s_mov_b32 s27, 0x20000
  v_mov_b32 v224, 0
  v_mov_b32 v225, 0
  v_mov_b32 v226, 0
  v_mov_b32 v227, 0
  v_mov_b32 v228, 0
  v_mov_b32 v229, 0
  v_mov_b32 v230, 0
  v_mov_b32 v231, 0
  v_lshlrev_b32 v14, 4, v1
  v_add_u32 v14, s10, v14
  ds_write_b128 v14, v[224:227] offset:5120
  ds_write_b128 v14, v[224:227] offset:6144
  ds_write_b128 v14, v[224:227] offset:7168
  v_mov_b32 v9, 0x3f80
  v_mov_b32 v247, 31
  v_mov_b32 v10, 0
  v_lshlrev_b32 v8, 4, v3
  v_mul_u32_u24 v246, 80, v2
  v_add_u32 v246, s10, v246
  v_lshlrev_b32 v6, 9, v3
  v_add_u32 v6, 152064, v6
  v_bfe_u32 v14, v1, 2, 2
  v_lshl_add_u32 v14, v3, 2, v14
  v_mul_u32_u24 v7, 80, v14
  v_bfe_u32 v14, v1, 4, 1
  v_lshl_add_u32 v7, v14, 5, v7
  v_and_b32 v14, 1, v1
  v_lshl_add_u32 v7, v14, 4, v7
  v_bfe_u32 v14, v1, 1, 1
  v_lshl_add_u32 v7, v14, 3, v7
  v_add_u32 v7, s10, v7
  v_mov_b32 v80, 0
  v_mov_b32 v81, 0
  s_and_b32 s8, s4, 3
  s_lshl_b32 s8, s8, 10
  s_add_u32 s66, s8, 147456
  v_and_b32 v236, 7, v1
  v_lshrrev_b32 v237, 3, v1
  v_lshlrev_b32 v238, 3, v1
  v_lshl_add_u32 v239, v236, 1, s66
  v_lshl_add_u32 v240, v237, 1, s66
  s_sub_u32 s68, 11, s4
  s_cmp_lt_u32 s4, 4
  s_cselect_b32 s68, s4, s68
  s_movk_i32 s72, 0xff
  s_mov_b32 s78, s4
  s_lshr_b32 s57, s62, 9
  s_mul_i32 s57, s57, 3840
  v_lshlrev_b32 v12, 5, v1
  v_add_u32 v12, s57, v12
  v_add_u32 v136, 0, v12
  v_add_u32 v137, 15360, v12
  v_add_u32 v138, 30720, v12
  v_add_u32 v139, 46080, v12
  v_add_u32 v140, 61440, v12
  v_add_u32 v141, 76800, v12
  v_add_u32 v142, 92160, v12
  v_add_u32 v143, 107520, v12
  v_add_u32 v144, 122880, v12
  v_add_u32 v145, 138240, v12
  v_mul_u32_u24 v13, 14336, v3
  v_add_u32 v13, v13, v12
  v_add_u32 v146, 2048, v13
  v_add_u32 v147, 32768, v13
  v_add_u32 v148, 63488, v13
  v_add_u32 v149, 94208, v13
  v_add_u32 v150, 124928, v13
  v_lshl_add_u32 v14, v1, 4, s66
  s_lshl_b32 s8, s4, 4
  s_add_u32 s67, s66, s8
  v_mov_b32 v159, s67
  v_lshl_add_u32 v164, v3, 6, s67
  v_lshrrev_b32 v13, 2, v2
  v_lshlrev_b32 v168, 2, v3
  v_xor_b32 v13, v13, v168
  v_cmp_eq_u32 s[40:41], 0, v13
  v_cmp_eq_u32 s[42:43], 1, v13
  v_cmp_eq_u32 s[44:45], 2, v13
  v_cmp_eq_u32 s[46:47], 3, v13
  v_mov_b32 v172, 0x3f80
  v_cndmask_b32 v168, v10, v172, s[40:41]
  v_cndmask_b32 v169, v10, v172, s[42:43]
  v_cndmask_b32 v170, v10, v172, s[44:45]
  v_cndmask_b32 v171, v10, v172, s[46:47]
  v_lshlrev_b32 v13, 4, v1
  v_add_u32 v13, 152064, v13
  ds_write_b128 v13, v[168:171]
  v_and_b32 v172, 3, v2
  v_mul_u32_u24 v172, 0x5555, v172
  ds_write_b32 v13, v172 offset:1024
  v_mov_b32 v168, 0x20000000
  v_writelane_b32 v168, 0, 63
  v_mov_b32 v169, 0x60004000
  v_writelane_b32 v169, 0, 63
  v_mov_b32 v170, 0xa0008000
  v_writelane_b32 v170, 0, 63
  v_mov_b32 v171, 0xe000c000
  v_writelane_b32 v171, 0, 63
  s_mul_i32 s8, s7, 2560000
  s_lshr_b32 s9, s2, 3
  s_mul_i32 s9, s9, 80000
  s_add_u32 s8, s8, s9
  s_add_u32 s8, s8, 4194304
  s_add_u32 s80, s34, s8
  s_addc_u32 s81, s35, 0
  s_mov_b32 s82, 80000
  s_mov_b32 s83, 0x20000
  s_lshl_b32 s9, s4, 13
  v_lshlrev_b32 v165, 7, v1
  v_add_u32 v165, s9, v165
  s_add_u32 s86, s7, 4
  s_lshl_b32 s86, s86, 3
  s_and_b32 s9, s2, 7
  s_add_u32 s86, s86, s9
  s_lshl_b32 s86, s86, 8
  s_add_u32 s86, s86, 16384
  v_mov_b32 v166, s86
  s_mov_b32 s86, 0
  s_cmp_lg_u32 s49, 0
  s_cbranch_scc1 K2_P1D
  v_mov_b32 v252, 0
  s_mov_b32 s53, 0x40000
K2_P1:
  global_load_dword v253, v252, s[50:51] offset:128 sc1
  s_waitcnt vmcnt(0)
  v_readfirstlane_b32 s9, v253
  s_cmp_lg_u32 s9, 0
  s_cbranch_scc1 K2_P1D
  s_sleep 2
  s_sub_u32 s53, s53, 1
  s_cbranch_scc0 K2_P1
K2_P1D:
  s_cmp_lg_u32 s55, 0
  s_cbranch_scc1 K2_P2D
  v_mov_b32 v252, 4
  s_mov_b32 s53, 0x40000
K2_P2:
  global_load_dword v253, v252, s[50:51] offset:128 sc1
  s_waitcnt vmcnt(0)
  v_readfirstlane_b32 s9, v253
  s_cmp_lg_u32 s9, 0
  s_cbranch_scc1 K2_P2D
  s_sleep 2
  s_sub_u32 s53, s53, 1
  s_cbranch_scc0 K2_P2
K2_P2D:
  s_cmp_lg_u32 s4, 0
  s_cbranch_scc1 K2_NP
  s_bfe_u32 s52, s2, 0x10002
  s_add_u32 s52, s52, 2
  s_cmp_lg_u32 s49, 0
  s_cbranch_scc1 K2_P3D
  v_mov_b32 v252, 0
  s_mov_b32 s53, 0x40000
K2_P3:
  global_load_dword v253, v252, s[50:51] offset:128 sc1
  s_waitcnt vmcnt(0)
  v_readfirstlane_b32 s9, v253
  s_cmp_lg_u32 s9, 0
  s_cbranch_scc1 K2_P3D
  s_sleep 2
  s_sub_u32 s53, s53, 1
  s_cbranch_scc0 K2_P3
K2_P3D:
  s_lshl_b32 s52, s52, 3
  s_and_b32 s9, s2, 7
  s_add_u32 s52, s52, s9
  s_lshl_b32 s52, s52, 8
  s_add_u32 s52, s52, 16384
  v_mov_b32 v252, s52
  s_mov_b32 s53, 0x40000
K2_C4:
  global_load_dword v253, v252, s[34:35] sc1
  s_waitcnt vmcnt(0)
  v_readfirstlane_b32 s9, v253
  s_cmp_ge_u32 s9, 40
  s_cbranch_scc1 K2_C4D
  s_sleep 2
  s_sub_u32 s53, s53, 1
  s_cbranch_scc0 K2_C4
K2_C4D:
  ds_write_b32 v250, v250 offset:52
  s_branch K2_NPD
K2_NP:
  ds_read_b32 v252, v250 offset:52
  s_waitcnt lgkmcnt(0)
  v_readfirstlane_b32 s9, v252
  s_cmp_lg_u32 s9, 0
  s_cbranch_scc1 K2_NPD
  s_sleep 1
  s_branch K2_NP
K2_NPD:
  s_setprio 3
  s_lshl_b32 s8, s63, 9
  buffer_load_dwordx4 v[152:155], v158, s[20:23], s8 offen offset:480 sc1
  s_mov_b32 s8, s62
  buffer_load_dword v88, v11, s[20:23], s8 offen sc1
  buffer_load_dword v89, v11, s[20:23], s8 offen offset:2048 sc1
  buffer_load_dword v98, v157, s[20:23], s8 offen offset:256 sc1
  s_add_u32 s8, s8, 4096
  buffer_load_dword v90, v11, s[20:23], s8 offen sc1
  buffer_load_dword v91, v11, s[20:23], s8 offen offset:2048 sc1
  buffer_load_dword v99, v157, s[20:23], s8 offen offset:256 sc1
  s_add_u32 s8, s8, 4096
  buffer_load_dword v92, v11, s[20:23], s8 offen sc1
  buffer_load_dword v93, v11, s[20:23], s8 offen offset:2048 sc1
  buffer_load_dword v100, v157, s[20:23], s8 offen offset:256 sc1
  s_add_u32 s8, s8, 4096
  buffer_load_dword v94, v11, s[20:23], s8 offen sc1
  buffer_load_dword v95, v11, s[20:23], s8 offen offset:2048 sc1
  buffer_load_dword v101, v157, s[20:23], s8 offen offset:256 sc1
  s_add_u32 s8, s8, 4096
  buffer_load_dword v96, v11, s[20:23], s8 offen sc1
  buffer_load_dword v97, v11, s[20:23], s8 offen offset:2048 sc1
  buffer_load_dword v102, v157, s[20:23], s8 offen offset:256 sc1
  s_lshl_b32 s9, s7, 11
  v_lshlrev_b32 v13, 4, v1
  v_add_u32 v13, s9, v13
  global_load_dwordx4 v[64:67], v13, s[34:35] offset:0 sc1
  global_load_dwordx4 v[68:71], v13, s[34:35] offset:1024 sc1
  v_mov_b32 v252, 1
  s_mov_b64 exec, 1
  ds_add_u32 v250, v252 offset:56
  s_mov_b64 exec, -1
  global_load_dword v167, v166, s[34:35] sc1
  s_waitcnt vmcnt(18)
  v_and_b32 v156, 0xc000, v152
  v_and_b32 v152, 0xffff3fff, v152
  v_cmp_ne_u32 vcc, 0, v156
  v_mov_b32 v160, v152
  v_mov_b32 v161, v153
  v_mov_b32 v162, v154
  v_mov_b32 v163, v155
  s_or_b32 s54, vcc_lo, vcc_hi
  v_cmp_lt_u32 vcc, 0x8000, v156
  v_add_u32_dpp v160, v160, v160 row_shr:1 row_mask:0xf bank_mask:0xf
  v_add_u32_dpp v161, v161, v161 row_shr:1 row_mask:0xf bank_mask:0xf
  v_add_u32_dpp v162, v162, v162 row_shr:1 row_mask:0xf bank_mask:0xf
  v_add_u32_dpp v163, v163, v163 row_shr:1 row_mask:0xf bank_mask:0xf
  s_or_b32 s48, vcc_lo, vcc_hi
  v_add_u32_dpp v160, v160, v160 row_shr:2 row_mask:0xf bank_mask:0xf
  v_add_u32_dpp v161, v161, v161 row_shr:2 row_mask:0xf bank_mask:0xf
  v_add_u32_dpp v162, v162, v162 row_shr:2 row_mask:0xf bank_mask:0xf
  v_add_u32_dpp v163, v163, v163 row_shr:2 row_mask:0xf bank_mask:0xf
  v_add_u32_dpp v160, v160, v160 row_shr:4 row_mask:0xf bank_mask:0xf
  v_add_u32_dpp v161, v161, v161 row_shr:4 row_mask:0xf bank_mask:0xf
  v_add_u32_dpp v162, v162, v162 row_shr:4 row_mask:0xf bank_mask:0xf
  v_add_u32_dpp v163, v163, v163 row_shr:4 row_mask:0xf bank_mask:0xf
  v_add_u32_dpp v160, v160, v160 row_shr:8 row_mask:0xf bank_mask:0xf
  v_add_u32_dpp v161, v161, v161 row_shr:8 row_mask:0xf bank_mask:0xf
  v_add_u32_dpp v162, v162, v162 row_shr:8 row_mask:0xf bank_mask:0xf
  v_add_u32_dpp v163, v163, v163 row_shr:8 row_mask:0xf bank_mask:0xf
  v_add_u32_dpp v160, v160, v160 row_bcast:15 row_mask:0xa bank_mask:0xf
  v_add_u32_dpp v161, v161, v161 row_bcast:15 row_mask:0xa bank_mask:0xf
  v_add_u32_dpp v162, v162, v162 row_bcast:15 row_mask:0xa bank_mask:0xf
  v_add_u32_dpp v163, v163, v163 row_bcast:15 row_mask:0xa bank_mask:0xf
  v_add_u32_dpp v160, v160, v160 row_bcast:31 row_mask:0xc bank_mask:0xf
  v_add_u32_dpp v161, v161, v161 row_bcast:31 row_mask:0xc bank_mask:0xf
  v_add_u32_dpp v162, v162, v162 row_bcast:31 row_mask:0xc bank_mask:0xf
  v_add_u32_dpp v163, v163, v163 row_bcast:31 row_mask:0xc bank_mask:0xf
  v_pk_max_u16 v13, v160, v161
  v_pk_max_u16 v156, v162, v163
  v_sub_u32 v160, v160, v152
  v_sub_u32 v161, v161, v153
  v_sub_u32 v162, v162, v154
  v_sub_u32 v163, v163, v155
  v_pk_max_u16 v13, v13, v156
  v_pk_add_u16 v160, v160, v168
  v_pk_add_u16 v161, v161, v169
  v_pk_add_u16 v162, v162, v170
  v_pk_add_u16 v163, v163, v171
  v_readlane_b32 s71, v13, 63
  v_writelane_b32 v160, s48, 62
  ds_write_b128 v14, v[160:163]
  s_and_b32 s8, s71, 0xffff
  s_lshr_b32 s71, s71, 16
  s_max_u32 s71, s71, s8
  s_waitcnt vmcnt(3)
  s_cmp_gt_u32 s71, 2048
  s_cbranch_scc1 K2_RARE
  s_cmp_lg_u32 s54, 0
  s_cbranch_scc1 K2_B3A
K2_B3AD:
  v_and_b32 v13, 7, v88
  v_lshl_add_u32 v120, v13, 1, v159
  v_and_b32 v13, 7, v89
  v_lshl_add_u32 v121, v13, 1, v159
  v_and_b32 v13, 7, v90
  v_lshl_add_u32 v122, v13, 1, v159
  v_and_b32 v13, 7, v91
  v_lshl_add_u32 v123, v13, 1, v159
  v_and_b32 v13, 7, v92
  v_lshl_add_u32 v124, v13, 1, v159
  v_and_b32 v13, 7, v93
  v_lshl_add_u32 v125, v13, 1, v159
  v_and_b32 v13, 7, v94
  v_lshl_add_u32 v126, v13, 1, v159
  v_and_b32 v13, 7, v95
  v_lshl_add_u32 v127, v13, 1, v159
  v_and_b32 v13, 7, v96
  v_lshl_add_u32 v128, v13, 1, v159
  v_and_b32 v13, 7, v97
  v_lshl_add_u32 v129, v13, 1, v159
  v_and_b32 v13, 7, v98
  v_lshl_add_u32 v130, v13, 1, v164
  v_and_b32 v13, 7, v99
  v_lshl_add_u32 v131, v13, 1, v164
  v_and_b32 v13, 7, v100
  v_lshl_add_u32 v132, v13, 1, v164
  v_and_b32 v13, 7, v101
  v_lshl_add_u32 v133, v13, 1, v164
  v_and_b32 v13, 7, v102
  v_lshl_add_u32 v134, v13, 1, v164
  ds_read_u16 v120, v120 offset:0
  ds_read_u16 v121, v121 offset:64
  ds_read_u16 v122, v122 offset:128
  ds_read_u16 v123, v123 offset:192
  ds_read_u16 v124, v124 offset:256
  ds_read_u16 v125, v125 offset:320
  ds_read_u16 v126, v126 offset:384
  ds_read_u16 v127, v127 offset:448
  ds_read_u16 v128, v128 offset:512
  ds_read_u16 v129, v129 offset:576
  ds_read_u16 v130, v130 offset:0
  ds_read_u16 v131, v131 offset:128
  ds_read_u16 v132, v132 offset:256
  ds_read_u16 v133, v133 offset:384
  ds_read_u16 v134, v134 offset:512
  s_cmp_lg_u32 s86, 0
  s_cbranch_scc1 K2_T0D
  s_waitcnt vmcnt(0)
  v_readfirstlane_b32 s9, v167
  s_cmp_ge_u32 s9, 40
  s_cbranch_scc1 K2_T0Y
  s_cmp_lg_u32 s4, 0
  s_cbranch_scc1 K2_T0D
  global_load_dword v167, v166, s[34:35] sc1
  s_branch K2_T0D
K2_T0Y:
  s_mov_b32 s86, 1
  s_mov_b32 s84, 0
  buffer_load_dword v255, v165, s[80:83], s84 offen sc1
K2_T0D:
  v_bfe_u32 v13, v88, 17, 5
  v_cmp_le_i32 s[16:17], 0, v88
  v_lshrrev_b32 v104, 22, v88
  v_add_u32 v136, v136, v13
  v_and_b32 v88, 0x1fff8, v88
  v_bfe_u32 v13, v89, 17, 5
  v_cmp_le_i32 s[18:19], 0, v89
  v_lshrrev_b32 v105, 22, v89
  v_add_u32 v137, v137, v13
  v_and_b32 v89, 0x1fff8, v89
  v_bfe_u32 v13, v90, 17, 5
  v_cmp_le_i32 s[28:29], 0, v90
  v_lshrrev_b32 v106, 22, v90
  v_add_u32 v138, v138, v13
  v_and_b32 v90, 0x1fff8, v90
  v_bfe_u32 v13, v91, 17, 5
  v_cmp_le_i32 s[30:31], 0, v91
  v_lshrrev_b32 v107, 22, v91
  v_add_u32 v139, v139, v13
  v_and_b32 v91, 0x1fff8, v91
  v_bfe_u32 v13, v92, 17, 5
  v_cmp_le_i32 s[36:37], 0, v92
  v_lshrrev_b32 v108, 22, v92
  v_add_u32 v140, v140, v13
  v_and_b32 v92, 0x1fff8, v92
  v_bfe_u32 v13, v93, 17, 5
  v_cmp_le_i32 s[38:39], 0, v93
  v_lshrrev_b32 v109, 22, v93
  v_add_u32 v141, v141, v13
  v_and_b32 v93, 0x1fff8, v93
  v_bfe_u32 v13, v94, 17, 5
  v_cmp_le_i32 s[40:41], 0, v94
  v_lshrrev_b32 v110, 22, v94
  v_add_u32 v142, v142, v13
  v_and_b32 v94, 0x1fff8, v94
  v_bfe_u32 v13, v95, 17, 5
  v_cmp_le_i32 s[42:43], 0, v95
  v_lshrrev_b32 v111, 22, v95
  v_add_u32 v143, v143, v13
  v_and_b32 v95, 0x1fff8, v95
  v_bfe_u32 v13, v96, 17, 5
  v_cmp_le_i32 s[44:45], 0, v96
  v_lshrrev_b32 v112, 22, v96
  v_add_u32 v144, v144, v13
  v_and_b32 v96, 0x1fff8, v96
  v_bfe_u32 v13, v97, 17, 5
  v_cmp_le_i32 s[46:47], 0, v97
  v_lshrrev_b32 v113, 22, v97
  v_add_u32 v145, v145, v13
  v_and_b32 v97, 0x1fff8, v97
  v_bfe_u32 v13, v98, 17, 5
  v_cmp_le_i32 s[56:57], 0, v98
  v_lshrrev_b32 v114, 22, v98
  v_add_u32 v146, v146, v13
  v_and_b32 v98, 0x1fff8, v98
  v_bfe_u32 v13, v99, 17, 5
  v_cmp_le_i32 s[58:59], 0, v99
  v_lshrrev_b32 v115, 22, v99
  v_add_u32 v147, v147, v13
  v_and_b32 v99, 0x1fff8, v99
  v_bfe_u32 v13, v100, 17, 5
  v_cmp_le_i32 s[60:61], 0, v100
  v_lshrrev_b32 v116, 22, v100
  v_add_u32 v148, v148, v13
  v_and_b32 v100, 0x1fff8, v100
  v_bfe_u32 v13, v101, 17, 5
  v_cmp_le_i32 s[70:71], 0, v101
  v_lshrrev_b32 v117, 22, v101
  v_add_u32 v149, v149, v13
  v_and_b32 v101, 0x1fff8, v101
  v_bfe_u32 v13, v102, 17, 5
  v_cmp_le_i32 s[74:75], 0, v102
  v_lshrrev_b32 v118, 22, v102
  v_add_u32 v150, v150, v13
  v_and_b32 v102, 0x1fff8, v102
  s_waitcnt lgkmcnt(0)
  v_lshl_add_u32 v120, v104, 2, v120
  v_lshl_add_u32 v121, v105, 2, v121
  v_lshl_add_u32 v122, v106, 2, v122
  v_lshl_add_u32 v123, v107, 2, v123
  v_lshl_add_u32 v124, v108, 2, v124
  v_lshl_add_u32 v125, v109, 2, v125
  v_lshl_add_u32 v126, v110, 2, v126
  v_lshl_add_u32 v127, v111, 2, v127
  v_lshl_add_u32 v128, v112, 2, v128
  v_lshl_add_u32 v129, v113, 2, v129
  v_lshl_add_u32 v130, v114, 2, v130
  v_lshl_add_u32 v131, v115, 2, v131
  v_lshl_add_u32 v132, v116, 2, v132
  v_lshl_add_u32 v133, v117, 2, v133
  v_lshl_add_u32 v134, v118, 2, v134
  s_mov_b64 exec, s[16:17]
  ds_write2st64_b32 v120, v88, v136 offset0:0 offset1:10
  s_mov_b64 exec, s[18:19]
  ds_write2st64_b32 v121, v89, v137 offset0:0 offset1:10
  s_mov_b64 exec, s[28:29]
  ds_write2st64_b32 v122, v90, v138 offset0:0 offset1:10
  s_mov_b64 exec, s[30:31]
  ds_write2st64_b32 v123, v91, v139 offset0:0 offset1:10
  s_mov_b64 exec, s[36:37]
  ds_write2st64_b32 v124, v92, v140 offset0:0 offset1:10
  s_mov_b64 exec, s[38:39]
  ds_write2st64_b32 v125, v93, v141 offset0:0 offset1:10
  s_mov_b64 exec, s[40:41]
  ds_write2st64_b32 v126, v94, v142 offset0:0 offset1:10
  s_mov_b64 exec, s[42:43]
  ds_write2st64_b32 v127, v95, v143 offset0:0 offset1:10
  s_mov_b64 exec, s[44:45]
  ds_write2st64_b32 v128, v96, v144 offset0:0 offset1:10
  s_mov_b64 exec, s[46:47]
  ds_write2st64_b32 v129, v97, v145 offset0:0 offset1:10
  s_mov_b64 exec, s[56:57]
  ds_write2st64_b32 v130, v98, v146 offset0:0 offset1:10
  s_mov_b64 exec, s[58:59]
  ds_write2st64_b32 v131, v99, v147 offset0:0 offset1:10
  s_mov_b64 exec, s[60:61]
  ds_write2st64_b32 v132, v100, v148 offset0:0 offset1:10
  s_mov_b64 exec, s[70:71]
  ds_write2st64_b32 v133, v101, v149 offset0:0 offset1:10
  s_mov_b64 exec, s[74:75]
  ds_write2st64_b32 v134, v102, v150 offset0:0 offset1:10
  s_mov_b64 exec, -1
  s_cmp_lg_u32 s54, 0
  s_cbranch_scc1 K2_B3B
K2_RARED:
  s_mov_b32 s65, 2
  s_cmp_lg_u32 s86, 0
  s_cbranch_scc1 K2_T2D
  s_cmp_lg_u32 s4, 0
  s_cbranch_scc1 K2_T2D
  s_mov_b32 s53, 0x40000
K2_T2R:
  s_waitcnt vmcnt(0)
  v_readfirstlane_b32 s9, v167
  s_cmp_ge_u32 s9, 40
  s_cbranch_scc1 K2_T2Y
  s_sleep 4
  global_load_dword v167, v166, s[34:35] sc1
  s_sub_u32 s53, s53, 1
  s_cbranch_scc0 K2_T2R
K2_T2Y:
  s_mov_b32 s86, 1
K2_T2D:
  ds_write_b32 v251, v9
  ds_read_u16 v241, v239 offset:1008
  ds_read_u16 v242, v240 offset:1008
  s_waitcnt lgkmcnt(0)
  v_lshl_add_u32 v243, v241, 3, v236
  v_lshl_add_u32 v242, v242, 3, v237
  v_cmp_gt_u32 vcc, v243, v242
  s_nop 1
  v_lshrrev_b64 v[244:245], v238, vcc
  v_and_b32 v244, s72, v244
  v_bcnt_u32_b32 v244, v244, 0
  v_cmp_eq_u32 vcc, s68, v244
  s_nop 0
  s_and_b32 s78, vcc_lo, s72
  s_ff1_i32_b32 s78, s78
  v_readlane_b32 s56, v241, s78
  s_add_u32 s5, s77, s78
  s_lshr_b32 s56, s56, 2
  s_mul_i32 s75, s78, 8192
  v_add_u32 v15, s75, v11
  s_cmp_gt_u32 s56, 512
  s_cselect_b32 s79, 1, 0
  s_cselect_b32 s56, 0, s56
  s_or_b32 s48, s48, s79
  s_cselect_b32 s58, 0, 80
  s_mov_b32 s59, 0
  s_mov_b32 s60, 0
K2_W5:
  ds_read_b128 v[172:175], v250 offset:0
  s_waitcnt lgkmcnt(0)
  v_min_u32 v172, v172, v173
  v_min3_u32 v172, v172, v174, v175
  s_nop 0
  v_readfirstlane_b32 s9, v172
  s_cmp_lt_u32 s9, 2
  s_cbranch_scc0 K2_W5D
  s_sleep 1
  s_branch K2_W5
K2_W5D:
  v_mov_b32 v14, 0x7fffffff
  v_lshl_add_u32 v13, s56, 2, v15
  s_mul_i32 s8, s5, 152
  v_mov_b32 v249, s8
  ds_write2st64_b32 v13, v249, v14 offset0:0 offset1:10
  ds_write2st64_b32 v13, v249, v14 offset0:1 offset1:11
  s_branch K2_PASS
K2_HI:
  s_and_b32 s62, s4, 3
  v_xor_b32 v13, v2, v3
  v_lshlrev_b32 v13, 4, v13
  v_lshl_add_u32 v13, v3, 9, v13
  s_and_b32 s8, s62, 1
  s_lshl_b32 s8, s8, 7
  v_xor_b32 v13, s8, v13
  v_xor_b32 v88, 0, v13
  v_xor_b32 v89, 32, v13
  v_add_u32 v89, 1024, v89
  v_xor_b32 v90, 64, v13
  v_add_u32 v90, 2048, v90
  v_xor_b32 v91, 96, v13
  v_add_u32 v91, 3072, v91
  s_lshl_b32 s67, s62, 12
  s_lshl_b32 s69, s64, 10
  s_add_u32 s69, s69, s67
  s_lshl_b32 s8, s7, 16
  s_lshl_b32 s9, s62, 14
  s_add_u32 s8, s8, s9
  s_add_u32 s70, s8, 65536
  v_lshlrev_b32 v12, 4, v1
  s_waitcnt lgkmcnt(0)
  s_mov_b32 s40, s38
  s_mov_b32 s41, s39
  s_mov_b32 s42, 5120000
  s_mov_b32 s43, 0x20000
  s_add_u32 s44, s34, s70
  s_addc_u32 s45, s35, 0
  s_mov_b32 s46, 16384
  s_mov_b32 s47, 0x20000
  s_add_u32 s20, s34, 524288
  s_addc_u32 s21, s35, 0
  s_mov_b32 s22, 2621440
  s_mov_b32 s23, 0x20000
  s_mul_i32 s8, s7, 2560000
  s_add_u32 s8, s8, 4194304
  s_add_u32 s12, s34, s8
  s_addc_u32 s13, s35, 0
  s_and_b32 s13, s13, 0xffff
  s_or_b32 s13, s13, 0x80000000
  s_mov_b32 s14, -1
  s_mov_b32 s15, 0xc00000
  s_add_u32 s24, s34, 16777216
  s_addc_u32 s25, s35, 0
  s_mov_b32 s26, 20971520
  s_mov_b32 s27, 0x20000
  v_mov_b32 v224, 0
  v_mov_b32 v225, 0
  v_mov_b32 v226, 0
  v_mov_b32 v227, 0
  v_mov_b32 v228, 0
  v_mov_b32 v229, 0
  v_mov_b32 v230, 0
  v_mov_b32 v231, 0
  v_lshlrev_b32 v14, 4, v1
  v_add_u32 v14, s10, v14
  ds_write_b128 v14, v[224:227] offset:5120
  ds_write_b128 v14, v[224:227] offset:6144
  ds_write_b128 v14, v[224:227] offset:7168
  v_mov_b32 v9, 0x3f80
  v_mov_b32 v247, 31
  v_mov_b32 v10, 0
  v_lshlrev_b32 v8, 4, v3
  v_mul_u32_u24 v246, 80, v2
  v_add_u32 v246, s10, v246
  v_lshlrev_b32 v6, 9, v3
  v_add_u32 v6, 152064, v6
  v_bfe_u32 v14, v1, 2, 2
  v_lshl_add_u32 v14, v3, 2, v14
  v_mul_u32_u24 v7, 80, v14
  v_bfe_u32 v14, v1, 4, 1
  v_lshl_add_u32 v7, v14, 5, v7
  v_and_b32 v14, 1, v1
  v_lshl_add_u32 v7, v14, 4, v7
  v_bfe_u32 v14, v1, 1, 1
  v_lshl_add_u32 v7, v14, 3, v7
  v_add_u32 v7, s10, v7
  v_mov_b32 v80, 0
  v_mov_b32 v81, 0
  s_and_b32 s8, s4, 3
  s_lshl_b32 s8, s8, 10
  s_add_u32 s66, s8, 147456
  v_and_b32 v236, 7, v1
  v_lshrrev_b32 v237, 3, v1
  v_lshlrev_b32 v238, 3, v1
  v_lshl_add_u32 v239, v236, 1, s66
  v_lshl_add_u32 v240, v237, 1, s66
  s_sub_u32 s68, 11, s4
  s_cmp_lt_u32 s4, 4
  s_cselect_b32 s68, s4, s68
  s_movk_i32 s72, 0xff
  s_mov_b32 s78, s4
  v_and_b32 v13, 15, v2
  v_xor_b32 v13, v13, v3
  v_lshlrev_b32 v13, 4, v13
  v_lshl_add_u32 v13, v2, 9, v13
  v_add_u32 v13, 65536, v13
  v_xor_b32 v48, 0, v13
  v_xor_b32 v49, 32, v13
  v_xor_b32 v50, 64, v13
  v_xor_b32 v51, 96, v13
  v_xor_b32 v52, 128, v13
  v_xor_b32 v53, 160, v13
  v_xor_b32 v54, 192, v13
  v_xor_b32 v55, 224, v13
  s_cmp_lt_u32 s62, 2
  s_cselect_b32 s8, 0xbfb8aa3b, 1.0
  v_mov_b32 v56, s8
  v_lshlrev_b32 v57, 10, v3
  v_lshl_add_u32 v57, v2, 2, v57
  s_lshl_b32 s8, s62, 7
  s_add_u32 s8, s8, 65536
  v_add_u32 v57, s8, v57
  s_setprio 3
  v_mov_b32 v96, 151600
  v_mov_b32 v97, 1
  v_mov_b32 v100, 0
  s_lshl_b32 s8, s3, 11
  s_add_u32 s8, s8, 16384
  v_and_b32 v98, 7, v0
  v_lshlrev_b32 v98, 8, v98
  v_add_u32 v98, s8, v98
  s_waitcnt vmcnt(0)
  s_mov_b64 exec, 1
  ds_add_rtn_u32 v99, v96, v97
  v_readfirstlane_b32 s49, v58
  v_readfirstlane_b32 s55, v59
  s_waitcnt lgkmcnt(0)
  v_readfirstlane_b32 s8, v99
  s_cmp_lg_u32 s8, 7
  s_cbranch_scc1 K2_FIN2
  s_cmp_eq_u32 s3, 9
  s_cbranch_scc1 K2_FA
  s_mov_b32 s53, 0x40000
K2_ZP:
  s_cmp_lg_u32 s49, 0
  s_cbranch_scc1 K2_ZD
  global_load_dword v99, v100, s[50:51] offset:128 sc1
  s_waitcnt vmcnt(0)
  v_readfirstlane_b32 s49, v99
  s_sub_u32 s53, s53, 1
  s_cbranch_scc0 K2_ZP
K2_ZD:
  s_mov_b64 exec, 0xff
  global_atomic_add v98, v97, s[34:35]
  s_mov_b64 exec, 1
  ds_add_u32 v96, v97
  s_branch K2_FIN2
K2_FA:
  global_atomic_add v99, v100, v97, s[50:51] sc0
  ds_add_u32 v96, v97
  s_waitcnt vmcnt(0)
  v_readfirstlane_b32 s8, v99
  s_cmp_lg_u32 s8, 15
  s_cbranch_scc1 K2_FIN2
  global_store_dword v100, v97, s[50:51] offset:132 sc0 sc1
K2_FIN2:
  s_setprio 0
  s_mov_b64 exec, -1
  s_cmp_lg_u32 s85, 2
  s_cbranch_scc1 K2_XLD
K2_XL:
  ds_read_b32 v252, v250 offset:60
  s_waitcnt lgkmcnt(0)
  v_readfirstlane_b32 s9, v252
  s_cmp_lt_u32 s9, 8
  s_cbranch_scc1 K2_XL
K2_XLD:
K2_WA:
  ds_read_b32 v252, v250 offset:48
  s_waitcnt lgkmcnt(0)
  v_readfirstlane_b32 s9, v252
  s_cmp_ge_u32 s9, 9
  s_cbranch_scc1 K2_WAD
  s_sleep 1
  s_branch K2_WA
K2_WAD:
  s_cmp_lg_u32 s85, 0
  s_cbranch_scc1 K2_PRE
  s_add_u32 m0, s67, 65536
  s_add_u32 s71, s69, 0
  buffer_load_dwordx4 v88, s[40:43], s71 offen lds
  s_add_u32 m0, s67, 66560
  s_add_u32 s71, s69, 0
  buffer_load_dwordx4 v89, s[40:43], s71 offen lds
  s_add_u32 m0, s67, 67584
  s_add_u32 s71, s69, 0
  buffer_load_dwordx4 v90, s[40:43], s71 offen lds
  s_add_u32 m0, s67, 68608
  s_add_u32 s71, s69, 0
  buffer_load_dwordx4 v91, s[40:43], s71 offen lds
  s_add_u32 m0, s67, 81920
  s_add_u32 s71, s69, 16384
  buffer_load_dwordx4 v88, s[40:43], s71 offen lds
  s_add_u32 m0, s67, 82944
  s_add_u32 s71, s69, 16384
  buffer_load_dwordx4 v89, s[40:43], s71 offen lds
  s_add_u32 m0, s67, 83968
  s_add_u32 s71, s69, 16384
  buffer_load_dwordx4 v90, s[40:43], s71 offen lds
  s_add_u32 m0, s67, 84992
  s_add_u32 s71, s69, 16384
  buffer_load_dwordx4 v91, s[40:43], s71 offen lds
  s_add_u32 m0, s67, 98304
  s_add_u32 s71, s69, 32768
  buffer_load_dwordx4 v88, s[40:43], s71 offen lds
  s_add_u32 m0, s67, 99328
  s_add_u32 s71, s69, 32768
  buffer_load_dwordx4 v89, s[40:43], s71 offen lds
  s_add_u32 m0, s67, 100352
  s_add_u32 s71, s69, 32768
  buffer_load_dwordx4 v90, s[40:43], s71 offen lds
  s_add_u32 m0, s67, 101376
  s_add_u32 s71, s69, 32768
  buffer_load_dwordx4 v91, s[40:43], s71 offen lds
  s_add_u32 m0, s67, 114688
  s_add_u32 s71, s69, 49152
  buffer_load_dwordx4 v88, s[40:43], s71 offen lds
  s_add_u32 m0, s67, 115712
  s_add_u32 s71, s69, 49152
  buffer_load_dwordx4 v89, s[40:43], s71 offen lds
  s_add_u32 m0, s67, 116736
  s_add_u32 s71, s69, 49152
  buffer_load_dwordx4 v90, s[40:43], s71 offen lds
  s_add_u32 m0, s67, 117760
  s_add_u32 s71, s69, 49152
  buffer_load_dwordx4 v91, s[40:43], s71 offen lds
  s_add_u32 m0, s67, 131072
  s_add_u32 s71, s69, 65536
  buffer_load_dwordx4 v88, s[40:43], s71 offen lds
  s_add_u32 m0, s67, 132096
  s_add_u32 s71, s69, 65536
  buffer_load_dwordx4 v89, s[40:43], s71 offen lds
  s_add_u32 m0, s67, 133120
  s_add_u32 s71, s69, 65536
  buffer_load_dwordx4 v90, s[40:43], s71 offen lds
  s_add_u32 m0, s67, 134144
  s_add_u32 s71, s69, 65536
  buffer_load_dwordx4 v91, s[40:43], s71 offen lds
K2_PRE:
  s_cmp_lg_u32 s55, 0
  s_cbranch_scc1 K2_P6D
  v_mov_b32 v252, 4
  s_mov_b32 s53, 0x40000
K2_P6:
  global_load_dword v253, v252, s[50:51] offset:128 sc1
  s_waitcnt vmcnt(0)
  v_readfirstlane_b32 s9, v253
  s_cmp_lg_u32 s9, 0
  s_cbranch_scc1 K2_P6D
  s_sleep 2
  s_sub_u32 s53, s53, 1
  s_cbranch_scc0 K2_P6
K2_P6D:
  s_lshl_b32 s9, s7, 11
  v_lshlrev_b32 v13, 4, v1
  v_add_u32 v13, s9, v13
  global_load_dwordx4 v[64:67], v13, s[34:35] offset:0 sc1
  global_load_dwordx4 v[68:71], v13, s[34:35] offset:1024 sc1
  s_movk_i32 s8, 0
  buffer_load_dwordx4 v[120:123], v12, s[44:47], s8 offen offset:0 sc1
  buffer_load_dwordx4 v[124:127], v12, s[44:47], s8 offen offset:1024 sc1
  buffer_load_dwordx4 v[128:131], v12, s[44:47], s8 offen offset:2048 sc1
  buffer_load_dwordx4 v[132:135], v12, s[44:47], s8 offen offset:3072 sc1
  s_movk_i32 s8, 4096
  buffer_load_dwordx4 v[136:139], v12, s[44:47], s8 offen offset:0 sc1
  buffer_load_dwordx4 v[140:143], v12, s[44:47], s8 offen offset:1024 sc1
  buffer_load_dwordx4 v[144:147], v12, s[44:47], s8 offen offset:2048 sc1
  buffer_load_dwordx4 v[148:151], v12, s[44:47], s8 offen offset:3072 sc1
  s_movk_i32 s8, 8192
  buffer_load_dwordx4 v[152:155], v12, s[44:47], s8 offen offset:0 sc1
  buffer_load_dwordx4 v[156:159], v12, s[44:47], s8 offen offset:1024 sc1
  buffer_load_dwordx4 v[160:163], v12, s[44:47], s8 offen offset:2048 sc1
  buffer_load_dwordx4 v[164:167], v12, s[44:47], s8 offen offset:3072 sc1
  s_movk_i32 s8, 12288
  buffer_load_dwordx4 v[168:171], v12, s[44:47], s8 offen offset:0 sc1
  buffer_load_dwordx4 v[172:175], v12, s[44:47], s8 offen offset:1024 sc1
  buffer_load_dwordx4 v[176:179], v12, s[44:47], s8 offen offset:2048 sc1
  buffer_load_dwordx4 v[180:183], v12, s[44:47], s8 offen offset:3072 sc1
  s_setprio 2
  s_waitcnt vmcnt(18)
  v_mov_b32 v14, 1
  ds_write_b32 v251, v14
K2_W7:
  ds_read_b128 v[252:255], v250 offset:16
  s_waitcnt lgkmcnt(0)
  v_min_u32 v252, v252, v253
  v_min3_u32 v252, v252, v254, v255
  s_nop 0
  v_readfirstlane_b32 s9, v252
  s_cmp_lt_u32 s9, 1
  s_cbranch_scc1 K2_W7
  ds_read_b128 v[72:75], v48 offset:0
  ds_read_b128 v[76:79], v49 offset:0
  ds_read_b128 v[80:83], v50 offset:0
  ds_read_b128 v[84:87], v51 offset:0
  ds_read_b128 v[96:99], v52 offset:0
  ds_read_b128 v[100:103], v53 offset:0
  ds_read_b128 v[104:107], v54 offset:0
  s_waitcnt vmcnt(14) lgkmcnt(5)
  v_mfma_f32_32x32x16_bf16 v[16:31], v[72:75], v[120:123], 0
  v_mov_b32 v14, 2
  ds_read_b128 v[108:111], v55 offset:0
  ds_write_b32 v251, v14
  v_mfma_f32_32x32x16_bf16 v[16:31], v[76:79], v[124:127], v[16:31]
  ds_read_b128 v[72:75], v48 offset:256
  s_waitcnt vmcnt(12) lgkmcnt(6)
  v_mfma_f32_32x32x16_bf16 v[16:31], v[80:83], v[128:131], v[16:31]
  ds_read_b128 v[76:79], v49 offset:256
  v_mfma_f32_32x32x16_bf16 v[16:31], v[84:87], v[132:135], v[16:31]
  ds_read_b128 v[80:83], v50 offset:256
  s_waitcnt vmcnt(10) lgkmcnt(6)
  v_mfma_f32_32x32x16_bf16 v[16:31], v[96:99], v[136:139], v[16:31]
  ds_read_b128 v[84:87], v51 offset:256
  v_mfma_f32_32x32x16_bf16 v[16:31], v[100:103], v[140:143], v[16:31]
  ds_read_b128 v[96:99], v52 offset:256
  s_waitcnt vmcnt(8) lgkmcnt(6)
  v_mfma_f32_32x32x16_bf16 v[16:31], v[104:107], v[144:147], v[16:31]
  ds_read_b128 v[100:103], v53 offset:256
  v_mfma_f32_32x32x16_bf16 v[16:31], v[108:111], v[148:151], v[16:31]
  ds_read_b128 v[104:107], v54 offset:256
  s_waitcnt vmcnt(6) lgkmcnt(5)
  v_mfma_f32_32x32x16_bf16 v[16:31], v[72:75], v[152:155], v[16:31]
  ds_read_b128 v[108:111], v55 offset:256
  v_mfma_f32_32x32x16_bf16 v[16:31], v[76:79], v[156:159], v[16:31]
  ds_read_b128 v[72:75], v48 offset:16384
  s_waitcnt vmcnt(4) lgkmcnt(5)
  v_mfma_f32_32x32x16_bf16 v[16:31], v[80:83], v[160:163], v[16:31]
  ds_read_b128 v[76:79], v49 offset:16384
  v_mfma_f32_32x32x16_bf16 v[16:31], v[84:87], v[164:167], v[16:31]
  ds_read_b128 v[80:83], v50 offset:16384
  s_waitcnt vmcnt(2) lgkmcnt(5)
  v_mfma_f32_32x32x16_bf16 v[16:31], v[96:99], v[168:171], v[16:31]
  ds_read_b128 v[84:87], v51 offset:16384
  v_mfma_f32_32x32x16_bf16 v[16:31], v[100:103], v[172:175], v[16:31]
  ds_read_b128 v[96:99], v52 offset:16384
  s_waitcnt vmcnt(0) lgkmcnt(5)
  v_mfma_f32_32x32x16_bf16 v[16:31], v[104:107], v[176:179], v[16:31]
  ds_read_b128 v[100:103], v53 offset:16384
  v_mfma_f32_32x32x16_bf16 v[16:31], v[108:111], v[180:183], v[16:31]
  ds_read_b128 v[104:107], v54 offset:16384
  s_waitcnt lgkmcnt(5)
  v_mfma_f32_32x32x16_bf16 v[32:47], v[72:75], v[120:123], 0
  v_mov_b32 v14, 3
  ds_read_b128 v[108:111], v55 offset:16384
  ds_write_b32 v251, v14
  v_mfma_f32_32x32x16_bf16 v[32:47], v[76:79], v[124:127], v[32:47]
  ds_read_b128 v[72:75], v48 offset:16640
  s_waitcnt lgkmcnt(6)
  v_mfma_f32_32x32x16_bf16 v[32:47], v[80:83], v[128:131], v[32:47]
  ds_read_b128 v[76:79], v49 offset:16640
  v_mfma_f32_32x32x16_bf16 v[32:47], v[84:87], v[132:135], v[32:47]
  v_mul_f32 v16, v56, v16
  v_mul_f32 v17, v56, v17
  v_cvt_pk_bf16_f32 v184, v16, v17
  ds_read_b128 v[80:83], v50 offset:16640
  s_waitcnt lgkmcnt(6)
  v_mfma_f32_32x32x16_bf16 v[32:47], v[96:99], v[136:139], v[32:47]
  v_mul_f32 v18, v56, v18
  v_mul_f32 v19, v56, v19
  v_cvt_pk_bf16_f32 v185, v18, v19
  ds_read_b128 v[84:87], v51 offset:16640
  v_mfma_f32_32x32x16_bf16 v[32:47], v[100:103], v[140:143], v[32:47]
  v_mul_f32 v20, v56, v20
  v_mul_f32 v21, v56, v21
  v_cvt_pk_bf16_f32 v186, v20, v21
  ds_read_b128 v[96:99], v52 offset:16640
  s_waitcnt lgkmcnt(6)
  v_mfma_f32_32x32x16_bf16 v[32:47], v[104:107], v[144:147], v[32:47]
  v_mul_f32 v22, v56, v22
  v_mul_f32 v23, v56, v23
  v_cvt_pk_bf16_f32 v187, v22, v23
  ds_read_b128 v[100:103], v53 offset:16640
  ds_read_b128 v[252:255], v250 offset:16
  v_mfma_f32_32x32x16_bf16 v[32:47], v[108:111], v[148:151], v[32:47]
  v_mul_f32 v24, v56, v24
  v_mul_f32 v25, v56, v25
  v_cvt_pk_bf16_f32 v188, v24, v25
  ds_read_b128 v[104:107], v54 offset:16640
  s_waitcnt lgkmcnt(6)
  v_mfma_f32_32x32x16_bf16 v[32:47], v[72:75], v[152:155], v[32:47]
  v_mul_f32 v26, v56, v26
  v_mul_f32 v27, v56, v27
  v_cvt_pk_bf16_f32 v189, v26, v27
  ds_read_b128 v[108:111], v55 offset:16640
  v_mfma_f32_32x32x16_bf16 v[32:47], v[76:79], v[156:159], v[32:47]
  v_mul_f32 v28, v56, v28
  v_mul_f32 v29, v56, v29
  v_cvt_pk_bf16_f32 v190, v28, v29
  ds_read_b128 v[72:75], v48 offset:32768
  s_waitcnt lgkmcnt(6)
  v_mfma_f32_32x32x16_bf16 v[32:47], v[80:83], v[160:163], v[32:47]
  v_mul_f32 v30, v56, v30
  v_mul_f32 v31, v56, v31
  v_cvt_pk_bf16_f32 v191, v30, v31
  ds_read_b128 v[76:79], v49 offset:32768
  v_mfma_f32_32x32x16_bf16 v[32:47], v[84:87], v[164:167], v[32:47]
  s_waitcnt lgkmcnt(4)
  v_min_u32 v252, v252, v253
  v_min3_u32 v252, v252, v254, v255
  v_cmp_gt_u32 vcc, 3, v252
  s_cbranch_vccnz K2_GS1
K2_GR1:
  ds_read_b128 v[80:83], v50 offset:32768
  ds_write2st64_b32 v57, v184, v185 offset0:0 offset1:2
  s_waitcnt lgkmcnt(7)
  v_mfma_f32_32x32x16_bf16 v[32:47], v[96:99], v[168:171], v[32:47]
  ds_read_b128 v[84:87], v51 offset:32768
  ds_write2st64_b32 v57, v186, v187 offset0:8 offset1:10
  v_mfma_f32_32x32x16_bf16 v[32:47], v[100:103], v[172:175], v[32:47]
  ds_read_b128 v[96:99], v52 offset:32768
  ds_write2st64_b32 v57, v188, v189 offset0:16 offset1:18
  s_waitcnt lgkmcnt(8)
  v_mfma_f32_32x32x16_bf16 v[32:47], v[104:107], v[176:179], v[32:47]
  ds_read_b128 v[100:103], v53 offset:32768
  ds_write2st64_b32 v57, v190, v191 offset0:24 offset1:26
  v_mfma_f32_32x32x16_bf16 v[32:47], v[108:111], v[180:183], v[32:47]
  ds_read_b128 v[104:107], v54 offset:32768
  s_waitcnt lgkmcnt(9)
  v_mfma_f32_32x32x16_bf16 v[16:31], v[72:75], v[120:123], 0
  v_mov_b32 v14, 4
  ds_read_b128 v[108:111], v55 offset:32768
  ds_write_b32 v251, v14
  v_mfma_f32_32x32x16_bf16 v[16:31], v[76:79], v[124:127], v[16:31]
  ds_read_b128 v[72:75], v48 offset:33024
  s_waitcnt lgkmcnt(9)
  v_mfma_f32_32x32x16_bf16 v[16:31], v[80:83], v[128:131], v[16:31]
  ds_read_b128 v[76:79], v49 offset:33024
  v_mfma_f32_32x32x16_bf16 v[16:31], v[84:87], v[132:135], v[16:31]
  v_mul_f32 v32, v56, v32
  v_mul_f32 v33, v56, v33
  v_cvt_pk_bf16_f32 v192, v32, v33
  ds_read_b128 v[80:83], v50 offset:33024
  s_waitcnt lgkmcnt(7)
  v_mfma_f32_32x32x16_bf16 v[16:31], v[96:99], v[136:139], v[16:31]
  v_mul_f32 v34, v56, v34
  v_mul_f32 v35, v56, v35
  v_cvt_pk_bf16_f32 v193, v34, v35
  ds_read_b128 v[84:87], v51 offset:33024
  v_mfma_f32_32x32x16_bf16 v[16:31], v[100:103], v[140:143], v[16:31]
  v_mul_f32 v36, v56, v36
  v_mul_f32 v37, v56, v37
  v_cvt_pk_bf16_f32 v194, v36, v37
  ds_read_b128 v[96:99], v52 offset:33024
  s_waitcnt lgkmcnt(6)
  v_mfma_f32_32x32x16_bf16 v[16:31], v[104:107], v[144:147], v[16:31]
  v_mul_f32 v38, v56, v38
  v_mul_f32 v39, v56, v39
  v_cvt_pk_bf16_f32 v195, v38, v39
  ds_read_b128 v[100:103], v53 offset:33024
  v_mfma_f32_32x32x16_bf16 v[16:31], v[108:111], v[148:151], v[16:31]
  v_mul_f32 v40, v56, v40
  v_mul_f32 v41, v56, v41
  v_cvt_pk_bf16_f32 v196, v40, v41
  ds_read_b128 v[104:107], v54 offset:33024
  s_waitcnt lgkmcnt(5)
  v_mfma_f32_32x32x16_bf16 v[16:31], v[72:75], v[152:155], v[16:31]
  v_mul_f32 v42, v56, v42
  v_mul_f32 v43, v56, v43
  v_cvt_pk_bf16_f32 v197, v42, v43
  ds_read_b128 v[108:111], v55 offset:33024
  v_mfma_f32_32x32x16_bf16 v[16:31], v[76:79], v[156:159], v[16:31]
  v_mul_f32 v44, v56, v44
  v_mul_f32 v45, v56, v45
  v_cvt_pk_bf16_f32 v198, v44, v45
  ds_read_b128 v[72:75], v48 offset:49152
  s_waitcnt lgkmcnt(5)
  v_mfma_f32_32x32x16_bf16 v[16:31], v[80:83], v[160:163], v[16:31]
  v_mul_f32 v46, v56, v46
  v_mul_f32 v47, v56, v47
  v_cvt_pk_bf16_f32 v199, v46, v47
  ds_read_b128 v[76:79], v49 offset:49152
  v_mfma_f32_32x32x16_bf16 v[16:31], v[84:87], v[164:167], v[16:31]
  ds_read_b128 v[80:83], v50 offset:49152
  ds_write2st64_b32 v57, v192, v193 offset0:32 offset1:34
  s_waitcnt lgkmcnt(6)
  v_mfma_f32_32x32x16_bf16 v[16:31], v[96:99], v[168:171], v[16:31]
  ds_read_b128 v[84:87], v51 offset:49152
  ds_write2st64_b32 v57, v194, v195 offset0:40 offset1:42
  v_mfma_f32_32x32x16_bf16 v[16:31], v[100:103], v[172:175], v[16:31]
  ds_read_b128 v[96:99], v52 offset:49152
  ds_write2st64_b32 v57, v196, v197 offset0:48 offset1:50
  s_waitcnt lgkmcnt(8)
  v_mfma_f32_32x32x16_bf16 v[16:31], v[104:107], v[176:179], v[16:31]
  ds_read_b128 v[100:103], v53 offset:49152
  ds_write2st64_b32 v57, v198, v199 offset0:56 offset1:58
  v_mfma_f32_32x32x16_bf16 v[16:31], v[108:111], v[180:183], v[16:31]
  ds_read_b128 v[104:107], v54 offset:49152
  s_waitcnt lgkmcnt(9)
  v_mfma_f32_32x32x16_bf16 v[32:47], v[72:75], v[120:123], 0
  v_mov_b32 v14, 5
  ds_read_b128 v[108:111], v55 offset:49152
  ds_write_b32 v251, v14
  v_mfma_f32_32x32x16_bf16 v[32:47], v[76:79], v[124:127], v[32:47]
  ds_read_b128 v[252:255], v250 offset:16
  ds_read_b128 v[72:75], v48 offset:49408
  s_waitcnt lgkmcnt(10)
  v_mfma_f32_32x32x16_bf16 v[32:47], v[80:83], v[128:131], v[32:47]
  v_add_u32 v48, 0x10000, v48
  ds_read_b128 v[76:79], v49 offset:49408
  v_mfma_f32_32x32x16_bf16 v[32:47], v[84:87], v[132:135], v[32:47]
  v_mul_f32 v16, v56, v16
  v_mul_f32 v17, v56, v17
  v_cvt_pk_bf16_f32 v184, v16, v17
  v_add_u32 v49, 0x10000, v49
  ds_read_b128 v[80:83], v50 offset:49408
  s_waitcnt lgkmcnt(8)
  v_mfma_f32_32x32x16_bf16 v[32:47], v[96:99], v[136:139], v[32:47]
  v_mul_f32 v18, v56, v18
  v_mul_f32 v19, v56, v19
  v_cvt_pk_bf16_f32 v185, v18, v19
  v_add_u32 v50, 0x10000, v50
  ds_read_b128 v[84:87], v51 offset:49408
  v_mfma_f32_32x32x16_bf16 v[32:47], v[100:103], v[140:143], v[32:47]
  v_mul_f32 v20, v56, v20
  v_mul_f32 v21, v56, v21
  v_cvt_pk_bf16_f32 v186, v20, v21
  v_add_u32 v51, 0x10000, v51
  ds_read_b128 v[96:99], v52 offset:49408
  s_waitcnt lgkmcnt(7)
  v_mfma_f32_32x32x16_bf16 v[32:47], v[104:107], v[144:147], v[32:47]
  v_mul_f32 v22, v56, v22
  v_mul_f32 v23, v56, v23
  v_cvt_pk_bf16_f32 v187, v22, v23
  v_add_u32 v52, 0x10000, v52
  ds_read_b128 v[100:103], v53 offset:49408
  v_mfma_f32_32x32x16_bf16 v[32:47], v[108:111], v[148:151], v[32:47]
  v_mul_f32 v24, v56, v24
  v_mul_f32 v25, v56, v25
  v_cvt_pk_bf16_f32 v188, v24, v25
  v_add_u32 v53, 0x10000, v53
  ds_read_b128 v[104:107], v54 offset:49408
  s_waitcnt lgkmcnt(5)
  v_mfma_f32_32x32x16_bf16 v[32:47], v[72:75], v[152:155], v[32:47]
  v_mul_f32 v26, v56, v26
  v_mul_f32 v27, v56, v27
  v_cvt_pk_bf16_f32 v189, v26, v27
  v_add_u32 v54, 0x10000, v54
  ds_read_b128 v[108:111], v55 offset:49408
  v_mfma_f32_32x32x16_bf16 v[32:47], v[76:79], v[156:159], v[32:47]
  v_mul_f32 v28, v56, v28
  v_mul_f32 v29, v56, v29
  v_cvt_pk_bf16_f32 v190, v28, v29
  v_add_u32 v55, 0x10000, v55
  ds_read_b128 v[72:75], v48 offset:0
  s_waitcnt lgkmcnt(5)
  v_mfma_f32_32x32x16_bf16 v[32:47], v[80:83], v[160:163], v[32:47]
  v_mul_f32 v30, v56, v30
  v_mul_f32 v31, v56, v31
  v_cvt_pk_bf16_f32 v191, v30, v31
  ds_read_b128 v[76:79], v49 offset:0
  v_mfma_f32_32x32x16_bf16 v[32:47], v[84:87], v[164:167], v[32:47]
  s_waitcnt lgkmcnt(10)
  v_min_u32 v252, v252, v253
  v_min3_u32 v252, v252, v254, v255
  v_cmp_gt_u32 vcc, 4, v252
  s_cbranch_vccnz K2_GS2
K2_GR2:
  ds_read_b128 v[80:83], v50 offset:0
  ds_write2st64_b32 v57, v184, v185 offset0:64 offset1:66
  s_waitcnt lgkmcnt(6)
  v_mfma_f32_32x32x16_bf16 v[32:47], v[96:99], v[168:171], v[32:47]
  ds_read_b128 v[84:87], v51 offset:0
  ds_write2st64_b32 v57, v186, v187 offset0:72 offset1:74
  v_mfma_f32_32x32x16_bf16 v[32:47], v[100:103], v[172:175], v[32:47]
  ds_read_b128 v[96:99], v52 offset:0
  ds_write2st64_b32 v57, v188, v189 offset0:80 offset1:82
  s_waitcnt lgkmcnt(8)
  v_mfma_f32_32x32x16_bf16 v[32:47], v[104:107], v[176:179], v[32:47]
  ds_read_b128 v[100:103], v53 offset:0
  ds_write2st64_b32 v57, v190, v191 offset0:88 offset1:90
  v_mfma_f32_32x32x16_bf16 v[32:47], v[108:111], v[180:183], v[32:47]
  ds_read_b128 v[104:107], v54 offset:0
  s_waitcnt lgkmcnt(9)
  v_mfma_f32_32x32x16_bf16 v[16:31], v[72:75], v[120:123], 0
  v_mov_b32 v14, 6
  ds_read_b128 v[108:111], v55 offset:0
  ds_write_b32 v251, v14
  v_mfma_f32_32x32x16_bf16 v[16:31], v[76:79], v[124:127], v[16:31]
  ds_read_b128 v[252:255], v250 offset:16
  ds_read_b128 v[72:75], v48 offset:256
  s_waitcnt lgkmcnt(10)
  v_mfma_f32_32x32x16_bf16 v[16:31], v[80:83], v[128:131], v[16:31]
  ds_read_b128 v[76:79], v49 offset:256
  v_mfma_f32_32x32x16_bf16 v[16:31], v[84:87], v[132:135], v[16:31]
  v_mul_f32 v32, v56, v32
  v_mul_f32 v33, v56, v33
  v_cvt_pk_bf16_f32 v192, v32, v33
  ds_read_b128 v[80:83], v50 offset:256
  s_waitcnt lgkmcnt(8)
  v_mfma_f32_32x32x16_bf16 v[16:31], v[96:99], v[136:139], v[16:31]
  v_mul_f32 v34, v56, v34
  v_mul_f32 v35, v56, v35
  v_cvt_pk_bf16_f32 v193, v34, v35
  ds_read_b128 v[84:87], v51 offset:256
  v_mfma_f32_32x32x16_bf16 v[16:31], v[100:103], v[140:143], v[16:31]
  v_mul_f32 v36, v56, v36
  v_mul_f32 v37, v56, v37
  v_cvt_pk_bf16_f32 v194, v36, v37
  ds_read_b128 v[96:99], v52 offset:256
  s_waitcnt lgkmcnt(7)
  v_mfma_f32_32x32x16_bf16 v[16:31], v[104:107], v[144:147], v[16:31]
  v_mul_f32 v38, v56, v38
  v_mul_f32 v39, v56, v39
  v_cvt_pk_bf16_f32 v195, v38, v39
  ds_read_b128 v[100:103], v53 offset:256
  v_mfma_f32_32x32x16_bf16 v[16:31], v[108:111], v[148:151], v[16:31]
  v_mul_f32 v40, v56, v40
  v_mul_f32 v41, v56, v41
  v_cvt_pk_bf16_f32 v196, v40, v41
  ds_read_b128 v[104:107], v54 offset:256
  s_waitcnt lgkmcnt(5)
  v_mfma_f32_32x32x16_bf16 v[16:31], v[72:75], v[152:155], v[16:31]
  v_mul_f32 v42, v56, v42
  v_mul_f32 v43, v56, v43
  v_cvt_pk_bf16_f32 v197, v42, v43
  ds_read_b128 v[108:111], v55 offset:256
  v_mfma_f32_32x32x16_bf16 v[16:31], v[76:79], v[156:159], v[16:31]
  v_mul_f32 v44, v56, v44
  v_mul_f32 v45, v56, v45
  v_cvt_pk_bf16_f32 v198, v44, v45
  s_waitcnt lgkmcnt(4)
  v_mfma_f32_32x32x16_bf16 v[16:31], v[80:83], v[160:163], v[16:31]
  v_mul_f32 v46, v56, v46
  v_mul_f32 v47, v56, v47
  v_cvt_pk_bf16_f32 v199, v46, v47
  v_mfma_f32_32x32x16_bf16 v[16:31], v[84:87], v[164:167], v[16:31]
  s_waitcnt lgkmcnt(8)
  v_min_u32 v252, v252, v253
  v_min3_u32 v252, v252, v254, v255
  v_cmp_gt_u32 vcc, 5, v252
  s_cbranch_vccnz K2_GS3
K2_GR3:
  ds_write2st64_b32 v57, v192, v193 offset0:96 offset1:98
  s_waitcnt lgkmcnt(3)
  v_mfma_f32_32x32x16_bf16 v[16:31], v[96:99], v[168:171], v[16:31]
  ds_write2st64_b32 v57, v194, v195 offset0:104 offset1:106
  v_mfma_f32_32x32x16_bf16 v[16:31], v[100:103], v[172:175], v[16:31]
  ds_write2st64_b32 v57, v196, v197 offset0:112 offset1:114
  s_waitcnt lgkmcnt(3)
  v_mfma_f32_32x32x16_bf16 v[16:31], v[104:107], v[176:179], v[16:31]
  ds_write2st64_b32 v57, v198, v199 offset0:120 offset1:122
  v_mfma_f32_32x32x16_bf16 v[16:31], v[108:111], v[180:183], v[16:31]
K2_GEND:
  s_nop 11
  v_mul_f32 v16, v56, v16
  v_mul_f32 v17, v56, v17
  v_cvt_pk_bf16_f32 v184, v16, v17
  v_mul_f32 v18, v56, v18
  v_mul_f32 v19, v56, v19
  v_cvt_pk_bf16_f32 v185, v18, v19
  v_mul_f32 v20, v56, v20
  v_mul_f32 v21, v56, v21
  v_cvt_pk_bf16_f32 v186, v20, v21
  v_mul_f32 v22, v56, v22
  v_mul_f32 v23, v56, v23
  v_cvt_pk_bf16_f32 v187, v22, v23
  v_mul_f32 v24, v56, v24
  v_mul_f32 v25, v56, v25
  v_cvt_pk_bf16_f32 v188, v24, v25
  v_mul_f32 v26, v56, v26
  v_mul_f32 v27, v56, v27
  v_cvt_pk_bf16_f32 v189, v26, v27
  v_mul_f32 v28, v56, v28
  v_mul_f32 v29, v56, v29
  v_cvt_pk_bf16_f32 v190, v28, v29
  v_mul_f32 v30, v56, v30
  v_mul_f32 v31, v56, v31
  v_cvt_pk_bf16_f32 v191, v30, v31
  ds_write2st64_b32 v57, v184, v185 offset0:128 offset1:130
  ds_write2st64_b32 v57, v186, v187 offset0:136 offset1:138
  ds_write2st64_b32 v57, v188, v189 offset0:144 offset1:146
  ds_write2st64_b32 v57, v190, v191 offset0:152 offset1:154
  v_mov_b32 v13, 7
  ds_write_b32 v251, v13
  s_setprio 0
K2_W8:
  ds_read_b128 v[252:255], v250 offset:0
  s_waitcnt lgkmcnt(0)
  v_min_u32 v252, v252, v253
  v_min3_u32 v252, v252, v254, v255
  s_nop 0
  v_readfirstlane_b32 s9, v252
  s_cmp_lt_u32 s9, 2
  s_cbranch_scc0 K2_W8D
  s_sleep 1
  s_branch K2_W8
K2_W8D:
  s_setprio 3
  ds_read_u16 v241, v239 offset:1008
  ds_read_u16 v242, v240 offset:1008
  v_mov_b32 v13, s66
  ds_read_b32 v14, v13 offset:992
  s_waitcnt lgkmcnt(0)
  v_readfirstlane_b32 s48, v14
  v_lshl_add_u32 v243, v241, 3, v236
  v_lshl_add_u32 v242, v242, 3, v237
  v_cmp_gt_u32 vcc, v243, v242
  s_nop 1
  v_lshrrev_b64 v[244:245], v238, vcc
  v_and_b32 v244, s72, v244
  v_bcnt_u32_b32 v244, v244, 0
  v_cmp_eq_u32 vcc, s68, v244
  s_nop 0
  s_and_b32 s78, vcc_lo, s72
  s_ff1_i32_b32 s78, s78
  v_readlane_b32 s56, v241, s78
  s_add_u32 s5, s77, s78
  s_lshr_b32 s56, s56, 2
  s_mul_i32 s75, s78, 8192
  v_add_u32 v15, s75, v11
  s_cmp_gt_u32 s56, 512
  s_cselect_b32 s79, 1, 0
  s_cselect_b32 s56, 0, s56
  s_or_b32 s48, s48, s79
  s_cselect_b32 s58, 0, 80
  s_mov_b32 s59, 0
  s_mov_b32 s60, 0
  s_mov_b32 s65, 1
  v_mov_b32 v14, 0x7fffffff
  v_lshl_add_u32 v13, s56, 2, v15
  s_mul_i32 s8, s5, 152
  v_mov_b32 v249, s8
  ds_write2st64_b32 v13, v249, v14 offset0:0 offset1:10
  ds_write2st64_b32 v13, v249, v14 offset0:1 offset1:11
K2_PASS:
  s_add_u32 s11, s56, 31
  s_lshr_b32 s11, s11, 5
  s_max_u32 s11, s11, 1
  s_sub_u32 s76, s11, 1
  s_lshl_b32 s76, s76, 5
  s_sub_u32 s76, s56, s76
  v_add_u32 v4, s75, v8
  v_lshl_add_u32 v5, v2, 2, s75
  ds_read_b128 v[192:195], v4 offset:0
  ds_read_b128 v[196:199], v4 offset:32
  ds_read_b128 v[200:203], v4 offset:64
  ds_read_b128 v[204:207], v4 offset:96
  ds_read_b32 v232, v5 offset:2560
  ds_read_b32 v234, v5 offset:2688
  s_waitcnt lgkmcnt(0)
  buffer_load_dword v88, v192, s[12:15], 0 offen offset:0 sc1
  buffer_load_dword v89, v193, s[12:15], 0 offen offset:0 sc1
  buffer_load_dword v90, v194, s[12:15], 0 offen offset:0 sc1
  buffer_load_dword v91, v195, s[12:15], 0 offen offset:0 sc1
  buffer_load_dword v92, v196, s[12:15], 0 offen offset:0 sc1
  buffer_load_dword v93, v197, s[12:15], 0 offen offset:0 sc1
  buffer_load_dword v94, v198, s[12:15], 0 offen offset:0 sc1
  buffer_load_dword v95, v199, s[12:15], 0 offen offset:0 sc1
  v_bitop3_b32 v249, v232, v247, v8 bitop3:0xba
  v_and_b32 v232, 31, v232
  v_lshl_add_u32 v233, v232, 1, v246
  v_lshl_add_u32 v232, v232, 4, v6
  buffer_load_dwordx4 v[208:211], v249, s[24:27], 0 offen sc1
  ds_write_b16 v233, v9 offset:5120
  ds_read_b128 v[216:219], v232
  ds_read_b32 v220, v232 offset:1024
  buffer_load_dword v96, v200, s[12:15], 0 offen offset:0 sc1
  buffer_load_dword v97, v201, s[12:15], 0 offen offset:0 sc1
  buffer_load_dword v98, v202, s[12:15], 0 offen offset:0 sc1
  buffer_load_dword v99, v203, s[12:15], 0 offen offset:0 sc1
  buffer_load_dword v100, v204, s[12:15], 0 offen offset:0 sc1
  buffer_load_dword v101, v205, s[12:15], 0 offen offset:0 sc1
  buffer_load_dword v102, v206, s[12:15], 0 offen offset:0 sc1
  buffer_load_dword v103, v207, s[12:15], 0 offen offset:0 sc1
  buffer_load_dword v104, v192, s[12:15], 0 offen offset:4 sc1
  buffer_load_dword v105, v193, s[12:15], 0 offen offset:4 sc1
  buffer_load_dword v106, v194, s[12:15], 0 offen offset:4 sc1
  buffer_load_dword v107, v195, s[12:15], 0 offen offset:4 sc1
  ds_read_b128 v[192:195], v4 offset:128
  buffer_load_dword v108, v196, s[12:15], 0 offen offset:4 sc1
  buffer_load_dword v109, v197, s[12:15], 0 offen offset:4 sc1
  buffer_load_dword v110, v198, s[12:15], 0 offen offset:4 sc1
  buffer_load_dword v111, v199, s[12:15], 0 offen offset:4 sc1
  ds_read_b128 v[196:199], v4 offset:160
  buffer_load_dword v112, v200, s[12:15], 0 offen offset:4 sc1
  buffer_load_dword v113, v201, s[12:15], 0 offen offset:4 sc1
  buffer_load_dword v114, v202, s[12:15], 0 offen offset:4 sc1
  buffer_load_dword v115, v203, s[12:15], 0 offen offset:4 sc1
  ds_read_b128 v[200:203], v4 offset:192
  buffer_load_dword v116, v204, s[12:15], 0 offen offset:4 sc1
  buffer_load_dword v117, v205, s[12:15], 0 offen offset:4 sc1
  buffer_load_dword v118, v206, s[12:15], 0 offen offset:4 sc1
  buffer_load_dword v119, v207, s[12:15], 0 offen offset:4 sc1
  ds_read_b128 v[204:207], v4 offset:224
  s_waitcnt lgkmcnt(0)
  buffer_load_dword v120, v192, s[12:15], 0 offen offset:0 sc1
  buffer_load_dword v121, v193, s[12:15], 0 offen offset:0 sc1
  buffer_load_dword v122, v194, s[12:15], 0 offen offset:0 sc1
  buffer_load_dword v123, v195, s[12:15], 0 offen offset:0 sc1
  buffer_load_dword v124, v196, s[12:15], 0 offen offset:0 sc1
  buffer_load_dword v125, v197, s[12:15], 0 offen offset:0 sc1
  buffer_load_dword v126, v198, s[12:15], 0 offen offset:0 sc1
  buffer_load_dword v127, v199, s[12:15], 0 offen offset:0 sc1
  v_bitop3_b32 v249, v234, v247, v8 bitop3:0xba
  v_and_b32 v234, 31, v234
  v_lshl_add_u32 v235, v234, 1, v246
  v_lshl_add_u32 v234, v234, 4, v6
  buffer_load_dwordx4 v[212:215], v249, s[24:27], 0 offen sc1
  s_waitcnt lgkmcnt(0)
  buffer_load_dword v128, v200, s[12:15], 0 offen offset:0 sc1
  buffer_load_dword v129, v201, s[12:15], 0 offen offset:0 sc1
  buffer_load_dword v130, v202, s[12:15], 0 offen offset:0 sc1
  buffer_load_dword v131, v203, s[12:15], 0 offen offset:0 sc1
  buffer_load_dword v132, v204, s[12:15], 0 offen offset:0 sc1
  buffer_load_dword v133, v205, s[12:15], 0 offen offset:0 sc1
  buffer_load_dword v134, v206, s[12:15], 0 offen offset:0 sc1
  buffer_load_dword v135, v207, s[12:15], 0 offen offset:0 sc1
  s_cmp_eq_u32 s65, 0
  s_cbranch_scc1 K2_NOXA
  s_mul_i32 s6, s5, 625
  s_add_u32 s8, s6, 688
  s_add_u32 s6, s6, 63
  s_lshr_b32 s6, s6, 6
  s_lshr_b32 s8, s8, 6
  s_sub_u32 s36, s8, s6
  s_sub_u32 s8, s6, s64
  s_add_u32 s73, s8, 73
  s_lshr_b32 s73, s73, 4
  s_min_u32 s73, s73, 7
  s_lshl_b32 s8, s8, 9
  s_add_u32 s8, s8, 65536
  v_lshl_add_u32 v12, v2, 2, s8
  v_lshl_add_u32 v13, v3, 11, v12
  v_lshl_add_u32 v14, v3, 9, v12
  v_add_u32 v12, 128, v13
  v_mov_b32 v26, 0
  v_mov_b32 v27, 0
  v_mov_b32 v28, 0
  v_mov_b32 v29, 0
  v_mov_b32 v30, 0
  v_mov_b32 v31, 0
  v_mov_b32 v53, 0
  v_mov_b32 v54, 0
  v_mov_b32 v55, 0
  v_mov_b32 v42, 0
  v_mov_b32 v43, 0
  v_mov_b32 v44, 0
  v_mov_b32 v45, 0
  v_mov_b32 v46, 0
  v_mov_b32 v47, 0
  v_mov_b32 v61, 0
  v_mov_b32 v62, 0
  v_mov_b32 v63, 0
  v_mov_b32 v184, 0
  v_mov_b32 v185, 0
  v_mov_b32 v186, 0
  v_mov_b32 v187, 0
  v_mov_b32 v72, 0
  v_mov_b32 v73, 0
  v_mov_b32 v74, 0
  v_mov_b32 v75, 0
  v_mov_b32 v76, 0
  v_mov_b32 v77, 0
  v_mov_b32 v78, 0
  v_mov_b32 v79, 0
  v_and_b32 v82, 1, v2
  v_mul_u32_u24 v81, 62, v82
  v_lshl_add_u32 v80, v2, 1, v81
  v_cmp_eq_u32 vcc, 1, v82
  v_lshl_add_u32 v81, v3, 10, v80
  v_lshl_add_u32 v80, v3, 12, v80
  v_add_u32 v81, 0x2000, v81
  v_mov_b32 v83, 0x05040100
  v_mov_b32 v82, 0x03020706
  v_cndmask_b32_e64 v82, v83, v82, vcc
  v_mov_b32 v84, 0xbfb8aa3b
  v_mov_b32 v85, 0xbfb8aa3b
  v_mov_b32 v86, 1.0
  v_mov_b32 v87, 1.0
K2_W9:
  ds_read_b128 v[180:183], v250 offset:16
  s_waitcnt lgkmcnt(0)
  v_min_u32 v180, v180, v181
  v_min3_u32 v180, v180, v182, v183
  s_nop 0
  v_readfirstlane_b32 s9, v180
  s_cmp_lt_u32 s9, s73
  s_cbranch_scc0 K2_W9D
  s_sleep 1
  s_branch K2_W9
K2_W9D:
  ds_read2st64_b32 v[48:49], v13 offset0:0 offset1:2
  ds_read2st64_b32 v[50:51], v13 offset0:4 offset1:6
  ds_read_b32 v52, v14 offset:4096
  ds_read2st64_b32 v[56:57], v12 offset0:0 offset1:2
  ds_read2st64_b32 v[58:59], v12 offset0:4 offset1:6
  ds_read_b32 v60, v14 offset:4224
  ds_read2st64_b32 v[168:169], v13 offset0:1 offset1:3
  ds_read2st64_b32 v[170:171], v13 offset0:5 offset1:7
  ds_read_b32 v172, v14 offset:4352
  ds_read2st64_b32 v[174:175], v12 offset0:1 offset1:3
  ds_read2st64_b32 v[176:177], v12 offset0:5 offset1:7
  ds_read_b32 v178, v14 offset:4480
  s_waitcnt lgkmcnt(0)
  v_lshlrev_b32 v16, 16, v168
  v_and_b32 v17, 0xffff0000, v168
  v_lshlrev_b32 v18, 16, v169
  v_and_b32 v19, 0xffff0000, v169
  v_lshlrev_b32 v20, 16, v170
  v_and_b32 v21, 0xffff0000, v170
  v_lshlrev_b32 v22, 16, v171
  v_and_b32 v23, 0xffff0000, v171
  v_lshlrev_b32 v24, 16, v172
  v_and_b32 v25, 0xffff0000, v172
  v_lshlrev_b32 v32, 16, v174
  v_and_b32 v33, 0xffff0000, v174
  v_lshlrev_b32 v34, 16, v175
  v_and_b32 v35, 0xffff0000, v175
  v_lshlrev_b32 v36, 16, v176
  v_and_b32 v37, 0xffff0000, v176
  v_lshlrev_b32 v38, 16, v177
  v_and_b32 v39, 0xffff0000, v177
  v_lshlrev_b32 v40, 16, v178
  v_and_b32 v41, 0xffff0000, v178
  s_mov_b32 s65, 0
K2_NOXA:
  s_waitcnt vmcnt(33) lgkmcnt(0)
  v_mov_b32 v188, 0
  v_mov_b32 v189, 0
  v_mov_b32 v190, 0
  v_mov_b32 v191, 0
  v_lshlrev_b64 v[152:153], 16, v[88:89]
  v_lshlrev_b64 v[154:155], 16, v[90:91]
  v_lshlrev_b64 v[156:157], 16, v[92:93]
  v_lshlrev_b64 v[158:159], 16, v[94:95]
  v_lshlrev_b64 v[160:161], 16, v[96:97]
  v_lshlrev_b64 v[162:163], 16, v[98:99]
  v_lshlrev_b64 v[164:165], 16, v[100:101]
  v_lshlrev_b64 v[166:167], 16, v[102:103]
  s_nop 1
  v_mfma_f32_32x32x16_bf16 v[152:167], v[208:211], v[64:67], v[152:167]
  v_smfmac_f32_32x32x32_bf16 v[152:167], v[216:219], v[48:55], v220
  v_add_u32 v5, 256, v5
  s_setprio 3
  s_nop 7
  s_cmp_eq_u32 s11, 1
  s_cbranch_scc1 K2_LAST0
  s_cmp_eq_u32 s11, 2
  s_cbranch_scc1 K2_PEN0
.p2align 6
K2_LOOP:
  v_exp_f32 v152, v152
  v_exp_f32 v153, v153
  v_mfma_f32_32x32x16_bf16 v[32:47], v[228:231], v[188:191], v[32:47]
  v_exp_f32 v154, v154
  v_exp_f32 v155, v155
  ds_read_b64_tr_b16 v[224:225], v7 offset:5120
  ds_read_b64_tr_b16 v[226:227], v7 offset:5760
  ds_read_b64_tr_b16 v[228:229], v7 offset:6400
  ds_read_b64_tr_b16 v[230:231], v7 offset:7040
  buffer_load_dword v136, v192, s[12:15], 0 offen offset:4 sc1
  buffer_load_dword v137, v193, s[12:15], 0 offen offset:4 sc1
  buffer_load_dword v138, v194, s[12:15], 0 offen offset:4 sc1
  buffer_load_dword v139, v195, s[12:15], 0 offen offset:4 sc1
  ds_read_b128 v[192:195], v4 offset:256
  v_exp_f32 v156, v156
  v_exp_f32 v157, v157
  v_exp_f32 v158, v158
  v_exp_f32 v159, v159
  v_exp_f32 v160, v160
  v_exp_f32 v161, v161
  v_exp_f32 v162, v162
  v_exp_f32 v163, v163
  v_exp_f32 v164, v164
  v_exp_f32 v165, v165
  v_exp_f32 v166, v166
  v_exp_f32 v167, v167
  v_pk_fma_f32 v[152:153], v[152:153], v[88:89], v[88:89]
  v_pk_fma_f32 v[154:155], v[154:155], v[90:91], v[90:91]
  buffer_load_dword v140, v196, s[12:15], 0 offen offset:4 sc1
  buffer_load_dword v141, v197, s[12:15], 0 offen offset:4 sc1
  buffer_load_dword v142, v198, s[12:15], 0 offen offset:4 sc1
  buffer_load_dword v143, v199, s[12:15], 0 offen offset:4 sc1
  ds_read_b128 v[196:199], v4 offset:288
  v_pk_fma_f32 v[156:157], v[156:157], v[92:93], v[92:93]
  v_pk_fma_f32 v[158:159], v[158:159], v[94:95], v[94:95]
  v_pk_fma_f32 v[160:161], v[160:161], v[96:97], v[96:97]
  v_pk_fma_f32 v[162:163], v[162:163], v[98:99], v[98:99]
  v_pk_fma_f32 v[164:165], v[164:165], v[100:101], v[100:101]
  v_pk_fma_f32 v[166:167], v[166:167], v[102:103], v[102:103]
  v_rcp_f32 v152, v152
  v_rcp_f32 v153, v153
  v_rcp_f32 v154, v154
  v_rcp_f32 v155, v155
  v_rcp_f32 v156, v156
  v_rcp_f32 v157, v157
  s_waitcnt vmcnt(25)
  v_lshlrev_b64 v[168:169], 16, v[104:105]
  v_lshlrev_b64 v[170:171], 16, v[106:107]
  v_lshlrev_b64 v[172:173], 16, v[108:109]
  v_lshlrev_b64 v[174:175], 16, v[110:111]
  v_lshlrev_b64 v[176:177], 16, v[112:113]
  v_lshlrev_b64 v[178:179], 16, v[114:115]
  v_lshlrev_b64 v[180:181], 16, v[116:117]
  v_lshlrev_b64 v[182:183], 16, v[118:119]
  v_rcp_f32 v158, v158
  v_rcp_f32 v159, v159
  v_mfma_f32_32x32x16_bf16 v[168:183], v[208:211], v[68:71], v[168:183]
  v_rcp_f32 v160, v160
  v_rcp_f32 v161, v161
  buffer_load_dword v144, v200, s[12:15], 0 offen offset:4 sc1
  buffer_load_dword v145, v201, s[12:15], 0 offen offset:4 sc1
  buffer_load_dword v146, v202, s[12:15], 0 offen offset:4 sc1
  buffer_load_dword v147, v203, s[12:15], 0 offen offset:4 sc1
  ds_read_b128 v[200:203], v4 offset:320
  v_rcp_f32 v162, v162
  v_rcp_f32 v163, v163
  v_smfmac_f32_32x32x32_bf16 v[168:183], v[216:219], v[56:63], v220
  v_rcp_f32 v164, v164
  v_rcp_f32 v165, v165
  v_rcp_f32 v166, v166
  v_rcp_f32 v167, v167
  buffer_load_dword v148, v204, s[12:15], 0 offen offset:4 sc1
  buffer_load_dword v149, v205, s[12:15], 0 offen offset:4 sc1
  buffer_load_dword v150, v206, s[12:15], 0 offen offset:4 sc1
  buffer_load_dword v151, v207, s[12:15], 0 offen offset:4 sc1
  ds_read_b128 v[204:207], v4 offset:352
  v_cvt_pk_bf16_f32 v184, v152, v153
  v_cvt_pk_bf16_f32 v185, v154, v155
  v_cvt_pk_bf16_f32 v186, v156, v157
  v_cvt_pk_bf16_f32 v187, v158, v159
  s_waitcnt lgkmcnt(4)
  v_cvt_pk_bf16_f32 v188, v160, v161
  v_cvt_pk_bf16_f32 v189, v162, v163
  v_mfma_f32_32x32x16_bf16 v[16:31], v[224:227], v[184:187], v[16:31]
  v_cvt_pk_bf16_f32 v190, v164, v165
  v_cvt_pk_bf16_f32 v191, v166, v167
  v_exp_f32 v168, v168
  v_exp_f32 v169, v169
  v_mfma_f32_32x32x16_bf16 v[16:31], v[228:231], v[188:191], v[16:31]
  v_exp_f32 v170, v170
  v_exp_f32 v171, v171
  ds_write_b16 v233, v10 offset:5120
  ds_write_b16 v235, v9 offset:5120
  ds_read_b128 v[216:219], v234
  ds_read_b32 v220, v234 offset:1024
  ds_read_b32 v232, v5 offset:2560
  s_waitcnt lgkmcnt(7)
  buffer_load_dword v88, v192, s[12:15], 0 offen offset:0 sc1
  buffer_load_dword v89, v193, s[12:15], 0 offen offset:0 sc1
  buffer_load_dword v90, v194, s[12:15], 0 offen offset:0 sc1
  buffer_load_dword v91, v195, s[12:15], 0 offen offset:0 sc1
  v_exp_f32 v172, v172
  v_exp_f32 v173, v173
  v_exp_f32 v174, v174
  v_exp_f32 v175, v175
  v_exp_f32 v176, v176
  v_exp_f32 v177, v177
  v_exp_f32 v178, v178
  v_exp_f32 v179, v179
  v_exp_f32 v180, v180
  v_exp_f32 v181, v181
  v_exp_f32 v182, v182
  v_exp_f32 v183, v183
  s_waitcnt lgkmcnt(0)
  v_bitop3_b32 v249, v232, v247, v8 bitop3:0xba
  v_and_b32 v232, 31, v232
  v_lshl_add_u32 v233, v232, 1, v246
  v_lshl_add_u32 v232, v232, 4, v6
  v_pk_fma_f32 v[168:169], v[168:169], v[104:105], v[104:105]
  v_pk_fma_f32 v[170:171], v[170:171], v[106:107], v[106:107]
  buffer_load_dword v92, v196, s[12:15], 0 offen offset:0 sc1
  buffer_load_dword v93, v197, s[12:15], 0 offen offset:0 sc1
  buffer_load_dword v94, v198, s[12:15], 0 offen offset:0 sc1
  buffer_load_dword v95, v199, s[12:15], 0 offen offset:0 sc1
  buffer_load_dwordx4 v[208:211], v249, s[24:27], 0 offen sc1
  v_pk_fma_f32 v[172:173], v[172:173], v[108:109], v[108:109]
  v_pk_fma_f32 v[174:175], v[174:175], v[110:111], v[110:111]
  v_pk_fma_f32 v[176:177], v[176:177], v[112:113], v[112:113]
  v_pk_fma_f32 v[178:179], v[178:179], v[114:115], v[114:115]
  v_pk_fma_f32 v[180:181], v[180:181], v[116:117], v[116:117]
  v_pk_fma_f32 v[182:183], v[182:183], v[118:119], v[118:119]
  v_rcp_f32 v168, v168
  v_rcp_f32 v169, v169
  v_rcp_f32 v170, v170
  v_rcp_f32 v171, v171
  v_rcp_f32 v172, v172
  v_rcp_f32 v173, v173
  s_waitcnt vmcnt(25) lgkmcnt(1)
  v_lshlrev_b64 v[152:153], 16, v[120:121]
  v_lshlrev_b64 v[154:155], 16, v[122:123]
  v_lshlrev_b64 v[156:157], 16, v[124:125]
  v_lshlrev_b64 v[158:159], 16, v[126:127]
  v_lshlrev_b64 v[160:161], 16, v[128:129]
  v_lshlrev_b64 v[162:163], 16, v[130:131]
  v_lshlrev_b64 v[164:165], 16, v[132:133]
  v_lshlrev_b64 v[166:167], 16, v[134:135]
  v_rcp_f32 v174, v174
  v_rcp_f32 v175, v175
  v_mfma_f32_32x32x16_bf16 v[152:167], v[212:215], v[64:67], v[152:167]
  v_rcp_f32 v176, v176
  v_rcp_f32 v177, v177
  s_waitcnt lgkmcnt(5)
  buffer_load_dword v96, v200, s[12:15], 0 offen offset:0 sc1
  buffer_load_dword v97, v201, s[12:15], 0 offen offset:0 sc1
  buffer_load_dword v98, v202, s[12:15], 0 offen offset:0 sc1
  buffer_load_dword v99, v203, s[12:15], 0 offen offset:0 sc1
  v_rcp_f32 v178, v178
  v_rcp_f32 v179, v179
  v_smfmac_f32_32x32x32_bf16 v[152:167], v[216:219], v[48:55], v220
  v_rcp_f32 v180, v180
  v_rcp_f32 v181, v181
  v_rcp_f32 v182, v182
  v_rcp_f32 v183, v183
  buffer_load_dword v100, v204, s[12:15], 0 offen offset:0 sc1
  buffer_load_dword v101, v205, s[12:15], 0 offen offset:0 sc1
  buffer_load_dword v102, v206, s[12:15], 0 offen offset:0 sc1
  buffer_load_dword v103, v207, s[12:15], 0 offen offset:0 sc1
  v_cvt_pk_bf16_f32 v184, v168, v169
  v_cvt_pk_bf16_f32 v185, v170, v171
  v_cvt_pk_bf16_f32 v186, v172, v173
  v_cvt_pk_bf16_f32 v187, v174, v175
  v_add_u32 v4, 128, v4
  v_add_u32 v5, 128, v5
  v_cvt_pk_bf16_f32 v188, v176, v177
  v_cvt_pk_bf16_f32 v189, v178, v179
  v_mfma_f32_32x32x16_bf16 v[32:47], v[224:227], v[184:187], v[32:47]
  v_cvt_pk_bf16_f32 v190, v180, v181
  v_cvt_pk_bf16_f32 v191, v182, v183
K2_MID:
  s_sub_u32 s11, s11, 1
  s_cmp_gt_u32 s11, 4
  s_cbranch_scc0 K2_PRX
K2_PRXD:
  v_exp_f32 v152, v152
  v_exp_f32 v153, v153
  v_mfma_f32_32x32x16_bf16 v[32:47], v[228:231], v[188:191], v[32:47]
  v_exp_f32 v154, v154
  v_exp_f32 v155, v155
  ds_read_b64_tr_b16 v[224:225], v7 offset:5120
  ds_read_b64_tr_b16 v[226:227], v7 offset:5760
  ds_read_b64_tr_b16 v[228:229], v7 offset:6400
  ds_read_b64_tr_b16 v[230:231], v7 offset:7040
  buffer_load_dword v104, v192, s[12:15], 0 offen offset:4 sc1
  buffer_load_dword v105, v193, s[12:15], 0 offen offset:4 sc1
  buffer_load_dword v106, v194, s[12:15], 0 offen offset:4 sc1
  buffer_load_dword v107, v195, s[12:15], 0 offen offset:4 sc1
  ds_read_b128 v[192:195], v4 offset:256
  v_exp_f32 v156, v156
  v_exp_f32 v157, v157
  v_exp_f32 v158, v158
  v_exp_f32 v159, v159
  v_exp_f32 v160, v160
  v_exp_f32 v161, v161
  v_exp_f32 v162, v162
  v_exp_f32 v163, v163
  v_exp_f32 v164, v164
  v_exp_f32 v165, v165
  v_exp_f32 v166, v166
  v_exp_f32 v167, v167
  v_pk_fma_f32 v[152:153], v[152:153], v[120:121], v[120:121]
  v_pk_fma_f32 v[154:155], v[154:155], v[122:123], v[122:123]
  buffer_load_dword v108, v196, s[12:15], 0 offen offset:4 sc1
  buffer_load_dword v109, v197, s[12:15], 0 offen offset:4 sc1
  buffer_load_dword v110, v198, s[12:15], 0 offen offset:4 sc1
  buffer_load_dword v111, v199, s[12:15], 0 offen offset:4 sc1
  ds_read_b128 v[196:199], v4 offset:288
  v_pk_fma_f32 v[156:157], v[156:157], v[124:125], v[124:125]
  v_pk_fma_f32 v[158:159], v[158:159], v[126:127], v[126:127]
  v_pk_fma_f32 v[160:161], v[160:161], v[128:129], v[128:129]
  v_pk_fma_f32 v[162:163], v[162:163], v[130:131], v[130:131]
  v_pk_fma_f32 v[164:165], v[164:165], v[132:133], v[132:133]
  v_pk_fma_f32 v[166:167], v[166:167], v[134:135], v[134:135]
  v_rcp_f32 v152, v152
  v_rcp_f32 v153, v153
  v_rcp_f32 v154, v154
  v_rcp_f32 v155, v155
  v_rcp_f32 v156, v156
  v_rcp_f32 v157, v157
  s_waitcnt vmcnt(25)
  v_lshlrev_b64 v[168:169], 16, v[136:137]
  v_lshlrev_b64 v[170:171], 16, v[138:139]
  v_lshlrev_b64 v[172:173], 16, v[140:141]
  v_lshlrev_b64 v[174:175], 16, v[142:143]
  v_lshlrev_b64 v[176:177], 16, v[144:145]
  v_lshlrev_b64 v[178:179], 16, v[146:147]
  v_lshlrev_b64 v[180:181], 16, v[148:149]
  v_lshlrev_b64 v[182:183], 16, v[150:151]
  v_rcp_f32 v158, v158
  v_rcp_f32 v159, v159
  v_mfma_f32_32x32x16_bf16 v[168:183], v[212:215], v[68:71], v[168:183]
  v_rcp_f32 v160, v160
  v_rcp_f32 v161, v161
  buffer_load_dword v112, v200, s[12:15], 0 offen offset:4 sc1
  buffer_load_dword v113, v201, s[12:15], 0 offen offset:4 sc1
  buffer_load_dword v114, v202, s[12:15], 0 offen offset:4 sc1
  buffer_load_dword v115, v203, s[12:15], 0 offen offset:4 sc1
  ds_read_b128 v[200:203], v4 offset:320
  v_rcp_f32 v162, v162
  v_rcp_f32 v163, v163
  v_smfmac_f32_32x32x32_bf16 v[168:183], v[216:219], v[56:63], v220
  v_rcp_f32 v164, v164
  v_rcp_f32 v165, v165
  v_rcp_f32 v166, v166
  v_rcp_f32 v167, v167
  buffer_load_dword v116, v204, s[12:15], 0 offen offset:4 sc1
  buffer_load_dword v117, v205, s[12:15], 0 offen offset:4 sc1
  buffer_load_dword v118, v206, s[12:15], 0 offen offset:4 sc1
  buffer_load_dword v119, v207, s[12:15], 0 offen offset:4 sc1
  ds_read_b128 v[204:207], v4 offset:352
  v_cvt_pk_bf16_f32 v184, v152, v153
  v_cvt_pk_bf16_f32 v185, v154, v155
  v_cvt_pk_bf16_f32 v186, v156, v157
  v_cvt_pk_bf16_f32 v187, v158, v159
  s_waitcnt lgkmcnt(4)
  v_cvt_pk_bf16_f32 v188, v160, v161
  v_cvt_pk_bf16_f32 v189, v162, v163
  v_mfma_f32_32x32x16_bf16 v[16:31], v[224:227], v[184:187], v[16:31]
  v_cvt_pk_bf16_f32 v190, v164, v165
  v_cvt_pk_bf16_f32 v191, v166, v167
  v_exp_f32 v168, v168
  v_exp_f32 v169, v169
  v_mfma_f32_32x32x16_bf16 v[16:31], v[228:231], v[188:191], v[16:31]
  v_exp_f32 v170, v170
  v_exp_f32 v171, v171
  ds_write_b16 v235, v10 offset:5120
  ds_write_b16 v233, v9 offset:5120
  ds_read_b128 v[216:219], v232
  ds_read_b32 v220, v232 offset:1024
  ds_read_b32 v234, v5 offset:2560
  s_waitcnt lgkmcnt(7)
  buffer_load_dword v120, v192, s[12:15], 0 offen offset:0 sc1
  buffer_load_dword v121, v193, s[12:15], 0 offen offset:0 sc1
  buffer_load_dword v122, v194, s[12:15], 0 offen offset:0 sc1
  buffer_load_dword v123, v195, s[12:15], 0 offen offset:0 sc1
  v_exp_f32 v172, v172
  v_exp_f32 v173, v173
  v_exp_f32 v174, v174
  v_exp_f32 v175, v175
  v_exp_f32 v176, v176
  v_exp_f32 v177, v177
  v_exp_f32 v178, v178
  v_exp_f32 v179, v179
  v_exp_f32 v180, v180
  v_exp_f32 v181, v181
  v_exp_f32 v182, v182
  v_exp_f32 v183, v183
  s_waitcnt lgkmcnt(0)
  v_bitop3_b32 v249, v234, v247, v8 bitop3:0xba
  v_and_b32 v234, 31, v234
  v_lshl_add_u32 v235, v234, 1, v246
  v_lshl_add_u32 v234, v234, 4, v6
  v_pk_fma_f32 v[168:169], v[168:169], v[136:137], v[136:137]
  v_pk_fma_f32 v[170:171], v[170:171], v[138:139], v[138:139]
  buffer_load_dword v124, v196, s[12:15], 0 offen offset:0 sc1
  buffer_load_dword v125, v197, s[12:15], 0 offen offset:0 sc1
  buffer_load_dword v126, v198, s[12:15], 0 offen offset:0 sc1
  buffer_load_dword v127, v199, s[12:15], 0 offen offset:0 sc1
  buffer_load_dwordx4 v[212:215], v249, s[24:27], 0 offen sc1
  v_pk_fma_f32 v[172:173], v[172:173], v[140:141], v[140:141]
  v_pk_fma_f32 v[174:175], v[174:175], v[142:143], v[142:143]
  v_pk_fma_f32 v[176:177], v[176:177], v[144:145], v[144:145]
  v_pk_fma_f32 v[178:179], v[178:179], v[146:147], v[146:147]
  v_pk_fma_f32 v[180:181], v[180:181], v[148:149], v[148:149]
  v_pk_fma_f32 v[182:183], v[182:183], v[150:151], v[150:151]
  v_rcp_f32 v168, v168
  v_rcp_f32 v169, v169
  v_rcp_f32 v170, v170
  v_rcp_f32 v171, v171
  v_rcp_f32 v172, v172
  v_rcp_f32 v173, v173
  s_waitcnt vmcnt(25) lgkmcnt(1)
  v_lshlrev_b64 v[152:153], 16, v[88:89]
  v_lshlrev_b64 v[154:155], 16, v[90:91]
  v_lshlrev_b64 v[156:157], 16, v[92:93]
  v_lshlrev_b64 v[158:159], 16, v[94:95]
  v_lshlrev_b64 v[160:161], 16, v[96:97]
  v_lshlrev_b64 v[162:163], 16, v[98:99]
  v_lshlrev_b64 v[164:165], 16, v[100:101]
  v_lshlrev_b64 v[166:167], 16, v[102:103]
  v_rcp_f32 v174, v174
  v_rcp_f32 v175, v175
  v_mfma_f32_32x32x16_bf16 v[152:167], v[208:211], v[64:67], v[152:167]
  v_rcp_f32 v176, v176
  v_rcp_f32 v177, v177
  s_waitcnt lgkmcnt(5)
  buffer_load_dword v128, v200, s[12:15], 0 offen offset:0 sc1
  buffer_load_dword v129, v201, s[12:15], 0 offen offset:0 sc1
  buffer_load_dword v130, v202, s[12:15], 0 offen offset:0 sc1
  buffer_load_dword v131, v203, s[12:15], 0 offen offset:0 sc1
  v_rcp_f32 v178, v178
  v_rcp_f32 v179, v179
  v_smfmac_f32_32x32x32_bf16 v[152:167], v[216:219], v[48:55], v220
  v_rcp_f32 v180, v180
  v_rcp_f32 v181, v181
  v_rcp_f32 v182, v182
  v_rcp_f32 v183, v183
  buffer_load_dword v132, v204, s[12:15], 0 offen offset:0 sc1
  buffer_load_dword v133, v205, s[12:15], 0 offen offset:0 sc1
  buffer_load_dword v134, v206, s[12:15], 0 offen offset:0 sc1
  buffer_load_dword v135, v207, s[12:15], 0 offen offset:0 sc1
  v_cvt_pk_bf16_f32 v184, v168, v169
  v_cvt_pk_bf16_f32 v185, v170, v171
  v_cvt_pk_bf16_f32 v186, v172, v173
  v_cvt_pk_bf16_f32 v187, v174, v175
  v_add_u32 v4, 128, v4
  v_add_u32 v5, 128, v5
  v_cvt_pk_bf16_f32 v188, v176, v177
  v_cvt_pk_bf16_f32 v189, v178, v179
  v_mfma_f32_32x32x16_bf16 v[32:47], v[224:227], v[184:187], v[32:47]
  v_cvt_pk_bf16_f32 v190, v180, v181
  v_cvt_pk_bf16_f32 v191, v182, v183
  s_sub_u32 s11, s11, 1
  s_cmp_gt_u32 s11, 4
  s_cbranch_scc1 K2_LOOP
  s_setprio 2
  s_cmp_gt_u32 s11, 2
  s_cbranch_scc1 K2_LOOP
  s_setprio 1
  s_cmp_gt_u32 s11, 2
  s_cbranch_scc1 K2_LOOP
K2_PEN0:
  v_exp_f32 v152, v152
  v_exp_f32 v153, v153
  v_mfma_f32_32x32x16_bf16 v[32:47], v[228:231], v[188:191], v[32:47]
  v_exp_f32 v154, v154
  v_exp_f32 v155, v155
  ds_read_b64_tr_b16 v[224:225], v7 offset:5120
  ds_read_b64_tr_b16 v[226:227], v7 offset:5760
  ds_read_b64_tr_b16 v[228:229], v7 offset:6400
  ds_read_b64_tr_b16 v[230:231], v7 offset:7040
  buffer_load_dword v136, v192, s[12:15], 0 offen offset:4 sc1
  buffer_load_dword v137, v193, s[12:15], 0 offen offset:4 sc1
  buffer_load_dword v138, v194, s[12:15], 0 offen offset:4 sc1
  buffer_load_dword v139, v195, s[12:15], 0 offen offset:4 sc1
  v_exp_f32 v156, v156
  v_exp_f32 v157, v157
  v_exp_f32 v158, v158
  v_exp_f32 v159, v159
  v_exp_f32 v160, v160
  v_exp_f32 v161, v161
  v_exp_f32 v162, v162
  v_exp_f32 v163, v163
  v_exp_f32 v164, v164
  v_exp_f32 v165, v165
  v_exp_f32 v166, v166
  v_exp_f32 v167, v167
  v_pk_fma_f32 v[152:153], v[152:153], v[88:89], v[88:89]
  v_pk_fma_f32 v[154:155], v[154:155], v[90:91], v[90:91]
  buffer_load_dword v140, v196, s[12:15], 0 offen offset:4 sc1
  buffer_load_dword v141, v197, s[12:15], 0 offen offset:4 sc1
  buffer_load_dword v142, v198, s[12:15], 0 offen offset:4 sc1
  buffer_load_dword v143, v199, s[12:15], 0 offen offset:4 sc1
  v_pk_fma_f32 v[156:157], v[156:157], v[92:93], v[92:93]
  v_pk_fma_f32 v[158:159], v[158:159], v[94:95], v[94:95]
  v_pk_fma_f32 v[160:161], v[160:161], v[96:97], v[96:97]
  v_pk_fma_f32 v[162:163], v[162:163], v[98:99], v[98:99]
  v_pk_fma_f32 v[164:165], v[164:165], v[100:101], v[100:101]
  v_pk_fma_f32 v[166:167], v[166:167], v[102:103], v[102:103]
  v_rcp_f32 v152, v152
  v_rcp_f32 v153, v153
  v_rcp_f32 v154, v154
  v_rcp_f32 v155, v155
  v_rcp_f32 v156, v156
  v_rcp_f32 v157, v157
  s_waitcnt vmcnt(25)
  v_lshlrev_b64 v[168:169], 16, v[104:105]
  v_lshlrev_b64 v[170:171], 16, v[106:107]
  v_lshlrev_b64 v[172:173], 16, v[108:109]
  v_lshlrev_b64 v[174:175], 16, v[110:111]
  v_lshlrev_b64 v[176:177], 16, v[112:113]
  v_lshlrev_b64 v[178:179], 16, v[114:115]
  v_lshlrev_b64 v[180:181], 16, v[116:117]
  v_lshlrev_b64 v[182:183], 16, v[118:119]
  v_rcp_f32 v158, v158
  v_rcp_f32 v159, v159
  v_mfma_f32_32x32x16_bf16 v[168:183], v[208:211], v[68:71], v[168:183]
  v_rcp_f32 v160, v160
  v_rcp_f32 v161, v161
  buffer_load_dword v144, v200, s[12:15], 0 offen offset:4 sc1
  buffer_load_dword v145, v201, s[12:15], 0 offen offset:4 sc1
  buffer_load_dword v146, v202, s[12:15], 0 offen offset:4 sc1
  buffer_load_dword v147, v203, s[12:15], 0 offen offset:4 sc1
  v_rcp_f32 v162, v162
  v_rcp_f32 v163, v163
  v_smfmac_f32_32x32x32_bf16 v[168:183], v[216:219], v[56:63], v220
  v_rcp_f32 v164, v164
  v_rcp_f32 v165, v165
  v_rcp_f32 v166, v166
  v_rcp_f32 v167, v167
  buffer_load_dword v148, v204, s[12:15], 0 offen offset:4 sc1
  buffer_load_dword v149, v205, s[12:15], 0 offen offset:4 sc1
  buffer_load_dword v150, v206, s[12:15], 0 offen offset:4 sc1
  buffer_load_dword v151, v207, s[12:15], 0 offen offset:4 sc1
  v_cvt_pk_bf16_f32 v184, v152, v153
  v_cvt_pk_bf16_f32 v185, v154, v155
  v_cvt_pk_bf16_f32 v186, v156, v157
  v_cvt_pk_bf16_f32 v187, v158, v159
  s_waitcnt lgkmcnt(0)
  v_cvt_pk_bf16_f32 v188, v160, v161
  v_cvt_pk_bf16_f32 v189, v162, v163
  v_mfma_f32_32x32x16_bf16 v[16:31], v[224:227], v[184:187], v[16:31]
  v_cvt_pk_bf16_f32 v190, v164, v165
  v_cvt_pk_bf16_f32 v191, v166, v167
  v_exp_f32 v168, v168
  v_exp_f32 v169, v169
  v_mfma_f32_32x32x16_bf16 v[16:31], v[228:231], v[188:191], v[16:31]
  v_exp_f32 v170, v170
  v_exp_f32 v171, v171
  ds_write_b16 v233, v10 offset:5120
  ds_write_b16 v235, v9 offset:5120
  ds_read_b128 v[216:219], v234
  ds_read_b32 v220, v234 offset:1024
  v_exp_f32 v172, v172
  v_exp_f32 v173, v173
  v_exp_f32 v174, v174
  v_exp_f32 v175, v175
  v_exp_f32 v176, v176
  v_exp_f32 v177, v177
  v_exp_f32 v178, v178
  v_exp_f32 v179, v179
  v_exp_f32 v180, v180
  v_exp_f32 v181, v181
  v_exp_f32 v182, v182
  v_exp_f32 v183, v183
  v_pk_fma_f32 v[168:169], v[168:169], v[104:105], v[104:105]
  v_pk_fma_f32 v[170:171], v[170:171], v[106:107], v[106:107]
  v_pk_fma_f32 v[172:173], v[172:173], v[108:109], v[108:109]
  v_pk_fma_f32 v[174:175], v[174:175], v[110:111], v[110:111]
  v_pk_fma_f32 v[176:177], v[176:177], v[112:113], v[112:113]
  v_pk_fma_f32 v[178:179], v[178:179], v[114:115], v[114:115]
  v_pk_fma_f32 v[180:181], v[180:181], v[116:117], v[116:117]
  v_pk_fma_f32 v[182:183], v[182:183], v[118:119], v[118:119]
  v_rcp_f32 v168, v168
  v_rcp_f32 v169, v169
  v_rcp_f32 v170, v170
  v_rcp_f32 v171, v171
  v_rcp_f32 v172, v172
  v_rcp_f32 v173, v173
  s_waitcnt vmcnt(16) lgkmcnt(0)
  v_lshlrev_b64 v[152:153], 16, v[120:121]
  v_lshlrev_b64 v[154:155], 16, v[122:123]
  v_lshlrev_b64 v[156:157], 16, v[124:125]
  v_lshlrev_b64 v[158:159], 16, v[126:127]
  v_lshlrev_b64 v[160:161], 16, v[128:129]
  v_lshlrev_b64 v[162:163], 16, v[130:131]
  v_lshlrev_b64 v[164:165], 16, v[132:133]
  v_lshlrev_b64 v[166:167], 16, v[134:135]
  v_rcp_f32 v174, v174
  v_rcp_f32 v175, v175
  v_mfma_f32_32x32x16_bf16 v[152:167], v[212:215], v[64:67], v[152:167]
  v_rcp_f32 v176, v176
  v_rcp_f32 v177, v177
  v_rcp_f32 v178, v178
  v_rcp_f32 v179, v179
  v_smfmac_f32_32x32x32_bf16 v[152:167], v[216:219], v[48:55], v220
  v_rcp_f32 v180, v180
  v_rcp_f32 v181, v181
  v_rcp_f32 v182, v182
  v_rcp_f32 v183, v183
  v_cvt_pk_bf16_f32 v184, v168, v169
  v_cvt_pk_bf16_f32 v185, v170, v171
  v_cvt_pk_bf16_f32 v186, v172, v173
  v_cvt_pk_bf16_f32 v187, v174, v175
  v_add_u32 v4, 128, v4
  v_add_u32 v5, 128, v5
  v_cvt_pk_bf16_f32 v188, v176, v177
  v_cvt_pk_bf16_f32 v189, v178, v179
  v_mfma_f32_32x32x16_bf16 v[32:47], v[224:227], v[184:187], v[32:47]
  v_cvt_pk_bf16_f32 v190, v180, v181
  v_cvt_pk_bf16_f32 v191, v182, v183
K2_LAST1:
  s_setprio 0
  s_waitcnt vmcnt(0)
  v_lshlrev_b64 v[168:169], 16, v[136:137]
  v_lshlrev_b64 v[170:171], 16, v[138:139]
  v_mfma_f32_32x32x16_bf16 v[32:47], v[228:231], v[188:191], v[32:47]
  v_lshlrev_b64 v[172:173], 16, v[140:141]
  v_lshlrev_b64 v[174:175], 16, v[142:143]
  v_lshlrev_b64 v[176:177], 16, v[144:145]
  v_lshlrev_b64 v[178:179], 16, v[146:147]
  v_lshlrev_b64 v[180:181], 16, v[148:149]
  v_lshlrev_b64 v[182:183], 16, v[150:151]
  v_exp_f32 v152, v152
  v_exp_f32 v153, v153
  v_mfma_f32_32x32x16_bf16 v[168:183], v[212:215], v[68:71], v[168:183]
  ds_read_b64_tr_b16 v[224:225], v7 offset:5120
  ds_read_b64_tr_b16 v[226:227], v7 offset:5760
  ds_read_b64_tr_b16 v[228:229], v7 offset:6400
  ds_read_b64_tr_b16 v[230:231], v7 offset:7040
  ds_write_b16 v235, v10 offset:5120
  v_exp_f32 v154, v154
  v_exp_f32 v155, v155
  v_smfmac_f32_32x32x32_bf16 v[168:183], v[216:219], v[56:63], v220
  v_pk_fma_f32 v[152:153], v[152:153], v[120:121], v[120:121]
  v_pk_fma_f32 v[154:155], v[154:155], v[122:123], v[122:123]
  v_rcp_f32 v152, v152
  v_rcp_f32 v153, v153
  v_rcp_f32 v154, v154
  v_rcp_f32 v155, v155
  s_nop 0
  v_cvt_pk_bf16_f32 v184, v152, v153
  v_cvt_pk_bf16_f32 v185, v154, v155
  s_nop 2
  v_exp_f32 v168, v168
  v_exp_f32 v169, v169
  v_exp_f32 v170, v170
  v_exp_f32 v171, v171
  v_pk_fma_f32 v[168:169], v[168:169], v[136:137], v[136:137]
  v_pk_fma_f32 v[170:171], v[170:171], v[138:139], v[138:139]
  v_rcp_f32 v168, v168
  v_rcp_f32 v169, v169
  v_rcp_f32 v170, v170
  v_rcp_f32 v171, v171
  s_nop 0
  v_cvt_pk_bf16_f32 v72, v168, v169
  v_cvt_pk_bf16_f32 v73, v170, v171
  s_cmp_le_u32 s76, 8
  s_cbranch_scc1 K2_LA1
  v_exp_f32 v156, v156
  v_exp_f32 v157, v157
  v_exp_f32 v158, v158
  v_exp_f32 v159, v159
  v_exp_f32 v172, v172
  v_exp_f32 v173, v173
  v_exp_f32 v174, v174
  v_exp_f32 v175, v175
  v_pk_fma_f32 v[156:157], v[156:157], v[124:125], v[124:125]
  v_pk_fma_f32 v[158:159], v[158:159], v[126:127], v[126:127]
  v_pk_fma_f32 v[172:173], v[172:173], v[140:141], v[140:141]
  v_pk_fma_f32 v[174:175], v[174:175], v[142:143], v[142:143]
  v_rcp_f32 v156, v156
  v_rcp_f32 v157, v157
  v_rcp_f32 v158, v158
  v_rcp_f32 v159, v159
  v_rcp_f32 v172, v172
  v_rcp_f32 v173, v173
  v_rcp_f32 v174, v174
  v_rcp_f32 v175, v175
  v_cvt_pk_bf16_f32 v186, v156, v157
  v_cvt_pk_bf16_f32 v187, v158, v159
  v_cvt_pk_bf16_f32 v74, v172, v173
  v_cvt_pk_bf16_f32 v75, v174, v175
  s_cmp_le_u32 s76, 16
  s_cbranch_scc1 K2_LA1
  s_waitcnt lgkmcnt(1)
  v_exp_f32 v160, v160
  v_mfma_f32_32x32x16_bf16 v[16:31], v[224:227], v[184:187], v[16:31]
  v_exp_f32 v161, v161
  v_exp_f32 v162, v162
  v_exp_f32 v163, v163
  v_exp_f32 v176, v176
  v_mfma_f32_32x32x16_bf16 v[32:47], v[224:227], v[72:75], v[32:47]
  v_exp_f32 v177, v177
  v_exp_f32 v178, v178
  v_exp_f32 v179, v179
  v_pk_fma_f32 v[160:161], v[160:161], v[128:129], v[128:129]
  v_pk_fma_f32 v[162:163], v[162:163], v[130:131], v[130:131]
  v_pk_fma_f32 v[176:177], v[176:177], v[144:145], v[144:145]
  v_pk_fma_f32 v[178:179], v[178:179], v[146:147], v[146:147]
  v_rcp_f32 v160, v160
  v_rcp_f32 v161, v161
  v_rcp_f32 v162, v162
  v_rcp_f32 v163, v163
  v_rcp_f32 v176, v176
  v_rcp_f32 v177, v177
  v_rcp_f32 v178, v178
  v_rcp_f32 v179, v179
  v_cvt_pk_bf16_f32 v188, v160, v161
  v_cvt_pk_bf16_f32 v189, v162, v163
  v_cvt_pk_bf16_f32 v76, v176, v177
  v_cvt_pk_bf16_f32 v77, v178, v179
  s_cmp_le_u32 s76, 24
  s_cbranch_scc1 K2_LB1
  v_exp_f32 v164, v164
  v_exp_f32 v165, v165
  v_exp_f32 v166, v166
  v_exp_f32 v167, v167
  v_exp_f32 v180, v180
  v_exp_f32 v181, v181
  v_exp_f32 v182, v182
  v_exp_f32 v183, v183
  v_pk_fma_f32 v[164:165], v[164:165], v[132:133], v[132:133]
  v_pk_fma_f32 v[166:167], v[166:167], v[134:135], v[134:135]
  v_pk_fma_f32 v[180:181], v[180:181], v[148:149], v[148:149]
  v_pk_fma_f32 v[182:183], v[182:183], v[150:151], v[150:151]
  v_rcp_f32 v164, v164
  v_rcp_f32 v165, v165
  v_rcp_f32 v166, v166
  v_rcp_f32 v167, v167
  v_rcp_f32 v180, v180
  v_rcp_f32 v181, v181
  v_rcp_f32 v182, v182
  v_rcp_f32 v183, v183
  v_cvt_pk_bf16_f32 v190, v164, v165
  v_cvt_pk_bf16_f32 v191, v166, v167
  v_cvt_pk_bf16_f32 v78, v180, v181
  v_cvt_pk_bf16_f32 v79, v182, v183
  s_nop 1
K2_LB1:
  v_mfma_f32_32x32x16_bf16 v[16:31], v[228:231], v[188:191], v[16:31]
  v_mfma_f32_32x32x16_bf16 v[32:47], v[228:231], v[76:79], v[32:47]
  s_branch K2_NEXT
K2_LA1:
  s_waitcnt lgkmcnt(0)
  v_mfma_f32_32x32x16_bf16 v[16:31], v[224:227], v[184:187], v[16:31]
  v_mfma_f32_32x32x16_bf16 v[32:47], v[224:227], v[72:75], v[32:47]
  s_branch K2_NEXT
K2_PEN1:
  v_exp_f32 v152, v152
  v_exp_f32 v153, v153
  v_mfma_f32_32x32x16_bf16 v[32:47], v[228:231], v[188:191], v[32:47]
  v_exp_f32 v154, v154
  v_exp_f32 v155, v155
  ds_read_b64_tr_b16 v[224:225], v7 offset:5120
  ds_read_b64_tr_b16 v[226:227], v7 offset:5760
  ds_read_b64_tr_b16 v[228:229], v7 offset:6400
  ds_read_b64_tr_b16 v[230:231], v7 offset:7040
  buffer_load_dword v104, v192, s[12:15], 0 offen offset:4 sc1
  buffer_load_dword v105, v193, s[12:15], 0 offen offset:4 sc1
  buffer_load_dword v106, v194, s[12:15], 0 offen offset:4 sc1
  buffer_load_dword v107, v195, s[12:15], 0 offen offset:4 sc1
  v_exp_f32 v156, v156
  v_exp_f32 v157, v157
  v_exp_f32 v158, v158
  v_exp_f32 v159, v159
  v_exp_f32 v160, v160
  v_exp_f32 v161, v161
  v_exp_f32 v162, v162
  v_exp_f32 v163, v163
  v_exp_f32 v164, v164
  v_exp_f32 v165, v165
  v_exp_f32 v166, v166
  v_exp_f32 v167, v167
  v_pk_fma_f32 v[152:153], v[152:153], v[120:121], v[120:121]
  v_pk_fma_f32 v[154:155], v[154:155], v[122:123], v[122:123]
  buffer_load_dword v108, v196, s[12:15], 0 offen offset:4 sc1
  buffer_load_dword v109, v197, s[12:15], 0 offen offset:4 sc1
  buffer_load_dword v110, v198, s[12:15], 0 offen offset:4 sc1
  buffer_load_dword v111, v199, s[12:15], 0 offen offset:4 sc1
  v_pk_fma_f32 v[156:157], v[156:157], v[124:125], v[124:125]
  v_pk_fma_f32 v[158:159], v[158:159], v[126:127], v[126:127]
  v_pk_fma_f32 v[160:161], v[160:161], v[128:129], v[128:129]
  v_pk_fma_f32 v[162:163], v[162:163], v[130:131], v[130:131]
  v_pk_fma_f32 v[164:165], v[164:165], v[132:133], v[132:133]
  v_pk_fma_f32 v[166:167], v[166:167], v[134:135], v[134:135]
  v_rcp_f32 v152, v152
  v_rcp_f32 v153, v153
  v_rcp_f32 v154, v154
  v_rcp_f32 v155, v155
  v_rcp_f32 v156, v156
  v_rcp_f32 v157, v157
  s_waitcnt vmcnt(25)
  v_lshlrev_b64 v[168:169], 16, v[136:137]
  v_lshlrev_b64 v[170:171], 16, v[138:139]
  v_lshlrev_b64 v[172:173], 16, v[140:141]
  v_lshlrev_b64 v[174:175], 16, v[142:143]
  v_lshlrev_b64 v[176:177], 16, v[144:145]
  v_lshlrev_b64 v[178:179], 16, v[146:147]
  v_lshlrev_b64 v[180:181], 16, v[148:149]
  v_lshlrev_b64 v[182:183], 16, v[150:151]
  v_rcp_f32 v158, v158
  v_rcp_f32 v159, v159
  v_mfma_f32_32x32x16_bf16 v[168:183], v[212:215], v[68:71], v[168:183]
  v_rcp_f32 v160, v160
  v_rcp_f32 v161, v161
  buffer_load_dword v112, v200, s[12:15], 0 offen offset:4 sc1
  buffer_load_dword v113, v201, s[12:15], 0 offen offset:4 sc1
  buffer_load_dword v114, v202, s[12:15], 0 offen offset:4 sc1
  buffer_load_dword v115, v203, s[12:15], 0 offen offset:4 sc1
  v_rcp_f32 v162, v162
  v_rcp_f32 v163, v163
  v_smfmac_f32_32x32x32_bf16 v[168:183], v[216:219], v[56:63], v220
  v_rcp_f32 v164, v164
  v_rcp_f32 v165, v165
  v_rcp_f32 v166, v166
  v_rcp_f32 v167, v167
  buffer_load_dword v116, v204, s[12:15], 0 offen offset:4 sc1
  buffer_load_dword v117, v205, s[12:15], 0 offen offset:4 sc1
  buffer_load_dword v118, v206, s[12:15], 0 offen offset:4 sc1
  buffer_load_dword v119, v207, s[12:15], 0 offen offset:4 sc1
  v_cvt_pk_bf16_f32 v184, v152, v153
  v_cvt_pk_bf16_f32 v185, v154, v155
  v_cvt_pk_bf16_f32 v186, v156, v157
  v_cvt_pk_bf16_f32 v187, v158, v159
  s_waitcnt lgkmcnt(0)
  v_cvt_pk_bf16_f32 v188, v160, v161
  v_cvt_pk_bf16_f32 v189, v162, v163
  v_mfma_f32_32x32x16_bf16 v[16:31], v[224:227], v[184:187], v[16:31]
  v_cvt_pk_bf16_f32 v190, v164, v165
  v_cvt_pk_bf16_f32 v191, v166, v167
  v_exp_f32 v168, v168
  v_exp_f32 v169, v169
  v_mfma_f32_32x32x16_bf16 v[16:31], v[228:231], v[188:191], v[16:31]
  v_exp_f32 v170, v170
  v_exp_f32 v171, v171
  ds_write_b16 v235, v10 offset:5120
  ds_write_b16 v233, v9 offset:5120
  ds_read_b128 v[216:219], v232
  ds_read_b32 v220, v232 offset:1024
  v_exp_f32 v172, v172
  v_exp_f32 v173, v173
  v_exp_f32 v174, v174
  v_exp_f32 v175, v175
  v_exp_f32 v176, v176
  v_exp_f32 v177, v177
  v_exp_f32 v178, v178
  v_exp_f32 v179, v179
  v_exp_f32 v180, v180
  v_exp_f32 v181, v181
  v_exp_f32 v182, v182
  v_exp_f32 v183, v183
  v_pk_fma_f32 v[168:169], v[168:169], v[136:137], v[136:137]
  v_pk_fma_f32 v[170:171], v[170:171], v[138:139], v[138:139]
  v_pk_fma_f32 v[172:173], v[172:173], v[140:141], v[140:141]
  v_pk_fma_f32 v[174:175], v[174:175], v[142:143], v[142:143]
  v_pk_fma_f32 v[176:177], v[176:177], v[144:145], v[144:145]
  v_pk_fma_f32 v[178:179], v[178:179], v[146:147], v[146:147]
  v_pk_fma_f32 v[180:181], v[180:181], v[148:149], v[148:149]
  v_pk_fma_f32 v[182:183], v[182:183], v[150:151], v[150:151]
  v_rcp_f32 v168, v168
  v_rcp_f32 v169, v169
  v_rcp_f32 v170, v170
  v_rcp_f32 v171, v171
  v_rcp_f32 v172, v172
  v_rcp_f32 v173, v173
  s_waitcnt vmcnt(16) lgkmcnt(0)
  v_lshlrev_b64 v[152:153], 16, v[88:89]
  v_lshlrev_b64 v[154:155], 16, v[90:91]
  v_lshlrev_b64 v[156:157], 16, v[92:93]
  v_lshlrev_b64 v[158:159], 16, v[94:95]
  v_lshlrev_b64 v[160:161], 16, v[96:97]
  v_lshlrev_b64 v[162:163], 16, v[98:99]
  v_lshlrev_b64 v[164:165], 16, v[100:101]
  v_lshlrev_b64 v[166:167], 16, v[102:103]
  v_rcp_f32 v174, v174
  v_rcp_f32 v175, v175
  v_mfma_f32_32x32x16_bf16 v[152:167], v[208:211], v[64:67], v[152:167]
  v_rcp_f32 v176, v176
  v_rcp_f32 v177, v177
  v_rcp_f32 v178, v178
  v_rcp_f32 v179, v179
  v_smfmac_f32_32x32x32_bf16 v[152:167], v[216:219], v[48:55], v220
  v_rcp_f32 v180, v180
  v_rcp_f32 v181, v181
  v_rcp_f32 v182, v182
  v_rcp_f32 v183, v183
  v_cvt_pk_bf16_f32 v184, v168, v169
  v_cvt_pk_bf16_f32 v185, v170, v171
  v_cvt_pk_bf16_f32 v186, v172, v173
  v_cvt_pk_bf16_f32 v187, v174, v175
  v_add_u32 v4, 128, v4
  v_add_u32 v5, 128, v5
  v_cvt_pk_bf16_f32 v188, v176, v177
  v_cvt_pk_bf16_f32 v189, v178, v179
  v_mfma_f32_32x32x16_bf16 v[32:47], v[224:227], v[184:187], v[32:47]
  v_cvt_pk_bf16_f32 v190, v180, v181
  v_cvt_pk_bf16_f32 v191, v182, v183
K2_LAST0:
  s_setprio 0
  s_waitcnt vmcnt(0)
  v_lshlrev_b64 v[168:169], 16, v[104:105]
  v_lshlrev_b64 v[170:171], 16, v[106:107]
  v_mfma_f32_32x32x16_bf16 v[32:47], v[228:231], v[188:191], v[32:47]
  v_lshlrev_b64 v[172:173], 16, v[108:109]
  v_lshlrev_b64 v[174:175], 16, v[110:111]
  v_lshlrev_b64 v[176:177], 16, v[112:113]
  v_lshlrev_b64 v[178:179], 16, v[114:115]
  v_lshlrev_b64 v[180:181], 16, v[116:117]
  v_lshlrev_b64 v[182:183], 16, v[118:119]
  v_exp_f32 v152, v152
  v_exp_f32 v153, v153
  v_mfma_f32_32x32x16_bf16 v[168:183], v[208:211], v[68:71], v[168:183]
  ds_read_b64_tr_b16 v[224:225], v7 offset:5120
  ds_read_b64_tr_b16 v[226:227], v7 offset:5760
  ds_read_b64_tr_b16 v[228:229], v7 offset:6400
  ds_read_b64_tr_b16 v[230:231], v7 offset:7040
  ds_write_b16 v233, v10 offset:5120
  v_exp_f32 v154, v154
  v_exp_f32 v155, v155
  v_smfmac_f32_32x32x32_bf16 v[168:183], v[216:219], v[56:63], v220
  v_pk_fma_f32 v[152:153], v[152:153], v[88:89], v[88:89]
  v_pk_fma_f32 v[154:155], v[154:155], v[90:91], v[90:91]
  v_rcp_f32 v152, v152
  v_rcp_f32 v153, v153
  v_rcp_f32 v154, v154
  v_rcp_f32 v155, v155
  s_nop 0
  v_cvt_pk_bf16_f32 v184, v152, v153
  v_cvt_pk_bf16_f32 v185, v154, v155
  s_nop 2
  v_exp_f32 v168, v168
  v_exp_f32 v169, v169
  v_exp_f32 v170, v170
  v_exp_f32 v171, v171
  v_pk_fma_f32 v[168:169], v[168:169], v[104:105], v[104:105]
  v_pk_fma_f32 v[170:171], v[170:171], v[106:107], v[106:107]
  v_rcp_f32 v168, v168
  v_rcp_f32 v169, v169
  v_rcp_f32 v170, v170
  v_rcp_f32 v171, v171
  s_nop 0
  v_cvt_pk_bf16_f32 v72, v168, v169
  v_cvt_pk_bf16_f32 v73, v170, v171
  s_cmp_le_u32 s76, 8
  s_cbranch_scc1 K2_LA0
  v_exp_f32 v156, v156
  v_exp_f32 v157, v157
  v_exp_f32 v158, v158
  v_exp_f32 v159, v159
  v_exp_f32 v172, v172
  v_exp_f32 v173, v173
  v_exp_f32 v174, v174
  v_exp_f32 v175, v175
  v_pk_fma_f32 v[156:157], v[156:157], v[92:93], v[92:93]
  v_pk_fma_f32 v[158:159], v[158:159], v[94:95], v[94:95]
  v_pk_fma_f32 v[172:173], v[172:173], v[108:109], v[108:109]
  v_pk_fma_f32 v[174:175], v[174:175], v[110:111], v[110:111]
  v_rcp_f32 v156, v156
  v_rcp_f32 v157, v157
  v_rcp_f32 v158, v158
  v_rcp_f32 v159, v159
  v_rcp_f32 v172, v172
  v_rcp_f32 v173, v173
  v_rcp_f32 v174, v174
  v_rcp_f32 v175, v175
  v_cvt_pk_bf16_f32 v186, v156, v157
  v_cvt_pk_bf16_f32 v187, v158, v159
  v_cvt_pk_bf16_f32 v74, v172, v173
  v_cvt_pk_bf16_f32 v75, v174, v175
  s_cmp_le_u32 s76, 16
  s_cbranch_scc1 K2_LA0
  s_waitcnt lgkmcnt(1)
  v_exp_f32 v160, v160
  v_mfma_f32_32x32x16_bf16 v[16:31], v[224:227], v[184:187], v[16:31]
  v_exp_f32 v161, v161
  v_exp_f32 v162, v162
  v_exp_f32 v163, v163
  v_exp_f32 v176, v176
  v_mfma_f32_32x32x16_bf16 v[32:47], v[224:227], v[72:75], v[32:47]
  v_exp_f32 v177, v177
  v_exp_f32 v178, v178
  v_exp_f32 v179, v179
  v_pk_fma_f32 v[160:161], v[160:161], v[96:97], v[96:97]
  v_pk_fma_f32 v[162:163], v[162:163], v[98:99], v[98:99]
  v_pk_fma_f32 v[176:177], v[176:177], v[112:113], v[112:113]
  v_pk_fma_f32 v[178:179], v[178:179], v[114:115], v[114:115]
  v_rcp_f32 v160, v160
  v_rcp_f32 v161, v161
  v_rcp_f32 v162, v162
  v_rcp_f32 v163, v163
  v_rcp_f32 v176, v176
  v_rcp_f32 v177, v177
  v_rcp_f32 v178, v178
  v_rcp_f32 v179, v179
  v_cvt_pk_bf16_f32 v188, v160, v161
  v_cvt_pk_bf16_f32 v189, v162, v163
  v_cvt_pk_bf16_f32 v76, v176, v177
  v_cvt_pk_bf16_f32 v77, v178, v179
  s_cmp_le_u32 s76, 24
  s_cbranch_scc1 K2_LB0
  v_exp_f32 v164, v164
  v_exp_f32 v165, v165
  v_exp_f32 v166, v166
  v_exp_f32 v167, v167
  v_exp_f32 v180, v180
  v_exp_f32 v181, v181
  v_exp_f32 v182, v182
  v_exp_f32 v183, v183
  v_pk_fma_f32 v[164:165], v[164:165], v[100:101], v[100:101]
  v_pk_fma_f32 v[166:167], v[166:167], v[102:103], v[102:103]
  v_pk_fma_f32 v[180:181], v[180:181], v[116:117], v[116:117]
  v_pk_fma_f32 v[182:183], v[182:183], v[118:119], v[118:119]
  v_rcp_f32 v164, v164
  v_rcp_f32 v165, v165
  v_rcp_f32 v166, v166
  v_rcp_f32 v167, v167
  v_rcp_f32 v180, v180
  v_rcp_f32 v181, v181
  v_rcp_f32 v182, v182
  v_rcp_f32 v183, v183
  v_cvt_pk_bf16_f32 v190, v164, v165
  v_cvt_pk_bf16_f32 v191, v166, v167
  v_cvt_pk_bf16_f32 v78, v180, v181
  v_cvt_pk_bf16_f32 v79, v182, v183
  s_nop 1
K2_LB0:
  v_mfma_f32_32x32x16_bf16 v[16:31], v[228:231], v[188:191], v[16:31]
  v_mfma_f32_32x32x16_bf16 v[32:47], v[228:231], v[76:79], v[32:47]
  s_branch K2_NEXT
K2_LA0:
  s_waitcnt lgkmcnt(0)
  v_mfma_f32_32x32x16_bf16 v[16:31], v[224:227], v[184:187], v[16:31]
  v_mfma_f32_32x32x16_bf16 v[32:47], v[224:227], v[72:75], v[32:47]
K2_NEXT:
  s_cmp_lt_u32 s59, s60
  s_cbranch_scc1 K2_OV
  s_cmp_lt_u32 s58, 80
  s_cbranch_scc1 K2_SRC
K2_EPI:
  s_lshl_b32 s8, s6, 10
  s_lshl_b32 s9, s7, 7
  s_add_u32 s8, s8, s9
  s_add_u32 s28, s32, s8
  s_addc_u32 s29, s33, 0
  s_mov_b32 s30, 0
  s_mov_b32 s31, 0x20000
  s_lshl_b32 s30, s36, 10
  s_sub_u32 s30, s30, 384
  v_pk_mul_f32 v[152:153], v[16:17], v[84:85]
  v_pk_mul_f32 v[154:155], v[18:19], v[84:85]
  v_pk_mul_f32 v[156:157], v[20:21], v[84:85]
  v_pk_mul_f32 v[168:169], v[32:33], v[84:85]
  v_pk_mul_f32 v[170:171], v[34:35], v[84:85]
  v_pk_mul_f32 v[172:173], v[36:37], v[84:85]
  v_exp_f32 v152, v152
  v_exp_f32 v153, v153
  v_exp_f32 v154, v154
  v_exp_f32 v155, v155
  v_exp_f32 v156, v156
  v_exp_f32 v157, v157
  v_exp_f32 v168, v168
  v_exp_f32 v169, v169
  v_exp_f32 v170, v170
  v_exp_f32 v171, v171
  v_exp_f32 v172, v172
  v_exp_f32 v173, v173
  v_pk_add_f32 v[152:153], v[152:153], v[86:87]
  v_pk_add_f32 v[154:155], v[154:155], v[86:87]
  v_pk_add_f32 v[156:157], v[156:157], v[86:87]
  v_pk_add_f32 v[168:169], v[168:169], v[86:87]
  v_pk_add_f32 v[170:171], v[170:171], v[86:87]
  v_pk_add_f32 v[172:173], v[172:173], v[86:87]
  v_rcp_f32 v152, v152
  v_rcp_f32 v153, v153
  v_rcp_f32 v154, v154
  v_rcp_f32 v155, v155
  v_rcp_f32 v156, v156
  v_rcp_f32 v157, v157
  v_rcp_f32 v168, v168
  v_rcp_f32 v169, v169
  v_rcp_f32 v170, v170
  v_rcp_f32 v171, v171
  v_rcp_f32 v172, v172
  v_rcp_f32 v173, v173
  v_pk_mul_f32 v[152:153], v[152:153], v[16:17]
  v_pk_mul_f32 v[154:155], v[154:155], v[18:19]
  v_pk_mul_f32 v[156:157], v[156:157], v[20:21]
  v_pk_mul_f32 v[168:169], v[168:169], v[32:33]
  v_pk_mul_f32 v[170:171], v[170:171], v[34:35]
  v_pk_mul_f32 v[172:173], v[172:173], v[36:37]
  v_cvt_pk_bf16_f32 v152, v152, v168
  v_cvt_pk_bf16_f32 v153, v153, v169
  v_cvt_pk_bf16_f32 v154, v154, v170
  v_cvt_pk_bf16_f32 v155, v155, v171
  v_cvt_pk_bf16_f32 v156, v156, v172
  v_cvt_pk_bf16_f32 v157, v157, v173
  v_mov_b32_dpp v168, v152 quad_perm:[1,0,3,2] row_mask:0xf bank_mask:0xf
  v_mov_b32_dpp v169, v153 quad_perm:[1,0,3,2] row_mask:0xf bank_mask:0xf
  v_mov_b32_dpp v170, v154 quad_perm:[1,0,3,2] row_mask:0xf bank_mask:0xf
  v_mov_b32_dpp v171, v155 quad_perm:[1,0,3,2] row_mask:0xf bank_mask:0xf
  v_mov_b32_dpp v172, v156 quad_perm:[1,0,3,2] row_mask:0xf bank_mask:0xf
  v_mov_b32_dpp v173, v157 quad_perm:[1,0,3,2] row_mask:0xf bank_mask:0xf
  v_perm_b32 v152, v168, v152, v82
  v_perm_b32 v153, v169, v153, v82
  v_perm_b32 v154, v170, v154, v82
  v_perm_b32 v155, v171, v155, v82
  v_perm_b32 v156, v172, v156, v82
  v_perm_b32 v157, v173, v157, v82
  buffer_store_dword v152, v80, s[28:31], 0 offen offset:0 sc1
  buffer_store_dword v153, v80, s[28:31], 0 offen offset:512 sc1
  buffer_store_dword v154, v80, s[28:31], 0 offen offset:1024 sc1
  buffer_store_dword v155, v80, s[28:31], 0 offen offset:1536 sc1
  buffer_store_dword v156, v80, s[28:31], 0 offen offset:2048 sc1
  buffer_store_dword v157, v80, s[28:31], 0 offen offset:2560 sc1
  v_pk_mul_f32 v[158:159], v[22:23], v[84:85]
  v_pk_mul_f32 v[160:161], v[24:25], v[84:85]
  v_pk_mul_f32 v[174:175], v[38:39], v[84:85]
  v_pk_mul_f32 v[176:177], v[40:41], v[84:85]
  v_exp_f32 v158, v158
  v_exp_f32 v159, v159
  v_exp_f32 v160, v160
  v_exp_f32 v161, v161
  v_exp_f32 v174, v174
  v_exp_f32 v175, v175
  v_exp_f32 v176, v176
  v_exp_f32 v177, v177
  v_pk_add_f32 v[158:159], v[158:159], v[86:87]
  v_pk_add_f32 v[160:161], v[160:161], v[86:87]
  v_pk_add_f32 v[174:175], v[174:175], v[86:87]
  v_pk_add_f32 v[176:177], v[176:177], v[86:87]
  v_rcp_f32 v158, v158
  v_rcp_f32 v159, v159
  v_rcp_f32 v160, v160
  v_rcp_f32 v161, v161
  v_rcp_f32 v174, v174
  v_rcp_f32 v175, v175
  v_rcp_f32 v176, v176
  v_rcp_f32 v177, v177
  v_pk_mul_f32 v[158:159], v[158:159], v[22:23]
  v_pk_mul_f32 v[160:161], v[160:161], v[24:25]
  v_pk_mul_f32 v[174:175], v[174:175], v[38:39]
  v_pk_mul_f32 v[176:177], v[176:177], v[40:41]
  v_cvt_pk_bf16_f32 v158, v158, v174
  v_cvt_pk_bf16_f32 v159, v159, v175
  v_cvt_pk_bf16_f32 v160, v160, v176
  v_cvt_pk_bf16_f32 v161, v161, v177
  v_mov_b32_dpp v174, v158 quad_perm:[1,0,3,2] row_mask:0xf bank_mask:0xf
  v_mov_b32_dpp v175, v159 quad_perm:[1,0,3,2] row_mask:0xf bank_mask:0xf
  v_mov_b32_dpp v176, v160 quad_perm:[1,0,3,2] row_mask:0xf bank_mask:0xf
  v_mov_b32_dpp v177, v161 quad_perm:[1,0,3,2] row_mask:0xf bank_mask:0xf
  v_perm_b32 v158, v174, v158, v82
  v_perm_b32 v159, v175, v159, v82
  v_perm_b32 v160, v176, v160, v82
  v_perm_b32 v161, v177, v161, v82
  buffer_store_dword v158, v80, s[28:31], 0 offen offset:3072 sc1
  buffer_store_dword v159, v80, s[28:31], 0 offen offset:3584 sc1
  buffer_store_dword v160, v81, s[28:31], 0 offen offset:0 sc1
  buffer_store_dword v161, v81, s[28:31], 0 offen offset:512 sc1
K2_END:
  s_endpgm
K2_B3A:
  s_mov_b32 s8, s62
  buffer_load_dword v176, v157, s[20:23], s8 offen offset:384 sc1
  s_add_u32 s8, s8, 4096
  buffer_load_dword v177, v157, s[20:23], s8 offen offset:384 sc1
  s_add_u32 s8, s8, 4096
  buffer_load_dword v178, v157, s[20:23], s8 offen offset:384 sc1
  s_add_u32 s8, s8, 4096
  buffer_load_dword v179, v157, s[20:23], s8 offen offset:384 sc1
  s_add_u32 s8, s8, 4096
  buffer_load_dword v180, v157, s[20:23], s8 offen offset:384 sc1
  s_add_u32 s8, s8, 4096
  s_branch K2_B3AD
K2_B3B:
  s_waitcnt vmcnt(0)
  v_and_b32 v13, 7, v176
  v_lshl_add_u32 v13, v13, 1, v164
  ds_read_u16 v120, v13 offset:0
  v_and_b32 v13, 7, v177
  v_lshl_add_u32 v13, v13, 1, v164
  ds_read_u16 v121, v13 offset:128
  v_and_b32 v13, 7, v178
  v_lshl_add_u32 v13, v13, 1, v164
  ds_read_u16 v122, v13 offset:256
  v_and_b32 v13, 7, v179
  v_lshl_add_u32 v13, v13, 1, v164
  ds_read_u16 v123, v13 offset:384
  v_and_b32 v13, 7, v180
  v_lshl_add_u32 v13, v13, 1, v164
  ds_read_u16 v124, v13 offset:512
  v_mul_u32_u24 v14, 14336, v3
  v_add_u32 v14, v14, v12
  s_waitcnt lgkmcnt(0)
  v_lshrrev_b32 v13, 22, v176
  v_lshl_add_u32 v120, v13, 2, v120
  s_mov_b32 s8, 3072
  v_cmpx_le_i32 vcc, 0, v176
  v_cmpx_gt_u32 vcc, 24, v2
  v_bfe_u32 v209, v176, 17, 5
  v_and_b32 v208, 0x1fff8, v176
  v_add3_u32 v209, v209, v14, s8
  ds_write2st64_b32 v120, v208, v209 offset0:0 offset1:10
  s_mov_b64 exec, -1
  v_lshrrev_b32 v13, 22, v177
  v_lshl_add_u32 v121, v13, 2, v121
  s_mov_b32 s8, 33792
  v_cmpx_le_i32 vcc, 0, v177
  v_cmpx_gt_u32 vcc, 24, v2
  v_bfe_u32 v209, v177, 17, 5
  v_and_b32 v208, 0x1fff8, v177
  v_add3_u32 v209, v209, v14, s8
  ds_write2st64_b32 v121, v208, v209 offset0:0 offset1:10
  s_mov_b64 exec, -1
  v_lshrrev_b32 v13, 22, v178
  v_lshl_add_u32 v122, v13, 2, v122
  s_mov_b32 s8, 64512
  v_cmpx_le_i32 vcc, 0, v178
  v_cmpx_gt_u32 vcc, 24, v2
  v_bfe_u32 v209, v178, 17, 5
  v_and_b32 v208, 0x1fff8, v178
  v_add3_u32 v209, v209, v14, s8
  ds_write2st64_b32 v122, v208, v209 offset0:0 offset1:10
  s_mov_b64 exec, -1
  v_lshrrev_b32 v13, 22, v179
  v_lshl_add_u32 v123, v13, 2, v123
  s_mov_b32 s8, 95232
  v_cmpx_le_i32 vcc, 0, v179
  v_cmpx_gt_u32 vcc, 24, v2
  v_bfe_u32 v209, v179, 17, 5
  v_and_b32 v208, 0x1fff8, v179
  v_add3_u32 v209, v209, v14, s8
  ds_write2st64_b32 v123, v208, v209 offset0:0 offset1:10
  s_mov_b64 exec, -1
  v_lshrrev_b32 v13, 22, v180
  v_lshl_add_u32 v124, v13, 2, v124
  s_mov_b32 s8, 125952
  v_cmpx_le_i32 vcc, 0, v180
  v_cmpx_gt_u32 vcc, 24, v2
  v_bfe_u32 v209, v180, 17, 5
  v_and_b32 v208, 0x1fff8, v180
  v_add3_u32 v209, v209, v14, s8
  ds_write2st64_b32 v124, v208, v209 offset0:0 offset1:10
  s_mov_b64 exec, -1
  s_branch K2_RARED
K2_RARE:
  s_mov_b32 s70, 0
K2_RL:
  s_lshr_b32 s71, s70, 1
  s_and_b32 s74, s70, 1
  s_lshl_b32 s8, s71, 11
  s_lshl_b32 s9, s74, 8
  s_add_u32 s8, s8, s9
  s_add_u32 s8, s8, s62
  buffer_load_dword v88, v11, s[20:23], s8 offen sc1
  s_lshl_b32 s8, s71, 6
  s_add_u32 s8, s8, s67
  s_waitcnt vmcnt(0)
  v_and_b32 v104, 7, v88
  v_lshl_add_u32 v13, v104, 1, s8
  ds_read_u16 v120, v13
  v_lshlrev_b32 v104, 13, v104
  v_lshrrev_b32 v13, 22, v88
  s_mul_i32 s8, s71, 15360
  s_lshl_b32 s9, s74, 11
  s_add_u32 s8, s8, s9
  s_lshl_b32 s9, s74, 6
  s_sub_u32 s9, 120, s9
  s_waitcnt lgkmcnt(0)
  v_sub_u32 v120, v120, v104
  v_and_b32 v120, 0xffff, v120
  v_lshl_add_u32 v120, v13, 2, v120
  v_min_u32 v120, 2556, v120
  v_add_u32 v120, v120, v104
  v_cmpx_le_i32 vcc, 0, v88
  v_cmpx_gt_u32 vcc, s9, v1
  v_bfe_u32 v209, v88, 17, 5
  v_and_b32 v208, 0x1fff8, v88
  v_add3_u32 v209, v209, v12, s8
  ds_write2st64_b32 v120, v208, v209 offset0:0 offset1:10
  s_mov_b64 exec, -1
  s_add_u32 s70, s70, 1
  s_cmp_lt_u32 s70, 20
  s_cbranch_scc1 K2_RL
  s_branch K2_RARED
K2_GS1:
K2_W10:
  ds_read_b128 v[252:255], v250 offset:16
  s_waitcnt lgkmcnt(0)
  v_min_u32 v252, v252, v253
  v_min3_u32 v252, v252, v254, v255
  s_nop 0
  v_readfirstlane_b32 s9, v252
  s_cmp_lt_u32 s9, 3
  s_cbranch_scc1 K2_W10
  s_branch K2_GR1
K2_GS2:
K2_W11:
  ds_read_b128 v[252:255], v250 offset:16
  s_waitcnt lgkmcnt(0)
  v_min_u32 v252, v252, v253
  v_min3_u32 v252, v252, v254, v255
  s_nop 0
  v_readfirstlane_b32 s9, v252
  s_cmp_lt_u32 s9, 4
  s_cbranch_scc1 K2_W11
  s_branch K2_GR2
K2_GS3:
K2_W12:
  ds_read_b128 v[252:255], v250 offset:16
  s_waitcnt lgkmcnt(0)
  v_min_u32 v252, v252, v253
  v_min3_u32 v252, v252, v254, v255
  s_nop 0
  v_readfirstlane_b32 s9, v252
  s_cmp_lt_u32 s9, 5
  s_cbranch_scc1 K2_W12
  s_branch K2_GR3
K2_PRX:
  s_setprio 2
  s_cmp_gt_u32 s11, 2
  s_cbranch_scc1 K2_PRXD
  s_setprio 1
  s_cmp_gt_u32 s11, 2
  s_cbranch_scc1 K2_PRXD
  s_branch K2_PEN1
K2_SRC:
  s_lshr_b32 s8, s58, 1
  s_add_u32 s9, s63, s8
  s_lshl_b32 s9, s9, 7
  s_bitcmp1_b32 s58, 0
  s_cbranch_scc1 K2_SRH
  s_add_u32 s58, s58, 1
  s_lshr_b32 s54, s9, 7
  s_mul_i32 s54, s54, 256
  s_mov_b32 s59, s9
  s_mul_i32 s60, s79, 120
  s_add_u32 s60, s60, s9
  s_branch K2_NEXT
K2_SRH:
  s_mov_b32 s54, 0
  s_add_u32 s58, s58, 1
  s_lshl_b32 s9, s9, 2
  s_add_u32 s9, s9, 524796
  v_mov_b32 v13, s9
  global_load_dword v13, v13, s[34:35] sc1
  s_waitcnt vmcnt(0)
  v_readfirstlane_b32 s37, v13
  s_lshl_b32 s8, s8, 13
  s_and_b32 s9, s2, 4
  s_lshl_b32 s9, s9, 10
  s_add_u32 s8, s8, s9
  s_add_u32 s8, s8, 327680
  s_and_b32 s59, s37, 0x1fff
  s_add_u32 s59, s59, s8
  s_bfe_u32 s60, s37, 0xd000d
  s_cmp_eq_u32 s37, -1
  s_cselect_b32 s60, 0, s60
  s_add_u32 s60, s60, s59
  s_branch K2_NEXT
K2_OV:
  s_mov_b32 s8, s59
  v_add_u32 v14, s8, v1
  v_lshlrev_b32 v13, 2, v14
  s_waitcnt vmcnt(0) lgkmcnt(0)
  buffer_load_dword v249, v13, s[20:23], 0 offen sc1
  v_lshlrev_b32 v14, 5, v14
  v_subrev_u32 v14, s54, v14
  s_sub_u32 s8, s60, s59
  s_add_u32 s59, s59, 64
  s_waitcnt vmcnt(0)
  v_and_b32 v13, 0x80000007, v249
  v_cmpx_gt_u32 vcc, s8, v1
  v_cmpx_eq_u32 vcc, s78, v13
  s_bcnt1_i32_b64 s56, exec
  s_nop 1
  v_mbcnt_lo_u32_b32 v13, exec_lo, 0
  v_mbcnt_hi_u32_b32 v13, exec_hi, v13
  v_lshl_add_u32 v13, v13, 2, s75
  v_bfe_u32 v209, v249, 17, 5
  v_and_b32 v208, 0x1fff8, v249
  v_add_u32 v209, v209, v14
  ds_write2st64_b32 v13, v208, v209 offset0:0 offset1:10
  s_mov_b64 exec, -1
  s_cmp_eq_u32 s56, 0
  s_cbranch_scc1 K2_NEXT
  v_mov_b32 v14, 0x7fffffff
  v_lshl_add_u32 v13, s56, 2, v15
  s_mul_i32 s8, s5, 152
  v_mov_b32 v249, s8
  ds_write2st64_b32 v13, v249, v14 offset0:0 offset1:10
  ds_write2st64_b32 v13, v249, v14 offset0:1 offset1:11
  s_branch K2_PASS
CODE_END:
.section .rodata,"a"
.p2align 6
.amdhsa_kernel gather_scatter__edge_featured_mpnn_egc__graph_kernel
  .amdhsa_next_free_vgpr 256
  .amdhsa_next_free_sgpr 102
  .amdhsa_accum_offset 256
  .amdhsa_group_segment_fixed_size 0
  .amdhsa_kernarg_size 80
  .amdhsa_user_sgpr_count 2
  .amdhsa_user_sgpr_kernarg_segment_ptr 1
  .amdhsa_system_sgpr_workgroup_id_x 1
.end_amdhsa_kernel
```
